```python
import torch

def _softmax(x, axis=-1):
    return torch.softmax(x, dim=axis)
def _gelu(x):
    return torch.nn.functional.gelu(x, approximate="tanh")
def _silu(x):
    return torch.nn.functional.silu(x)
def _sigmoid(x):
    return torch.sigmoid(x)
def _layernorm(x, axis=-1, eps=1e-5):
    m = x.mean(dim=axis, keepdim=True)
    v = x.var(dim=axis, keepdim=True, unbiased=False)
    return (x - m) / torch.sqrt(v + eps)
def _scatter_add(tgt, idx, src, axis=0):
    return tgt.clone().index_add_(axis, idx, src)
def _segment_sum(src, seg, n):
    out = torch.zeros((n,) + src.shape[1:], dtype=src.dtype)
    return out.index_add_(0, seg, src)
def _pad(x, pw):
    flat = tuple(v for pair in reversed(pw) for v in pair)
    return torch.nn.functional.pad(x, flat)

kernel_name = 'sequential_preLN__ssm_conv_s4d__moe_arch_mod__prompt'

def setup_inputs():

    _w = (lambda a: (lambda t: t.to(torch.bfloat16) if t.is_floating_point() else t)(torch.as_tensor(a)))
    def _A_setup():
        Bsz, L, D, N = 1, 2048, 640, 128
        return {
            "u": _w((lambda *s: torch.randn(*s, dtype=torch.bfloat16) * 0.05)(Bsz, L, D)),
            "log_A_real": _w((lambda *s: torch.randn(*s, dtype=torch.bfloat16) * 6.4)(D, N) * 0.5),
            "A_imag": _w((lambda *s: torch.randn(*s, dtype=torch.bfloat16) * 0.05)(D, N) * 3.14),
            "C_real": _w((lambda *s: torch.randn(*s, dtype=torch.bfloat16) * 0.05)(D, N) / N ** 0.5),
            "C_imag": _w((lambda *s: torch.randn(*s, dtype=torch.bfloat16) * 0.05)(D, N) / N ** 0.5),
            "log_dt": _w((lambda *s: torch.randn(*s, dtype=torch.bfloat16) * 0.05)(D) * 0.5 - 4.0),
            "D_skip": _w((lambda *s: torch.randn(*s, dtype=torch.bfloat16) * 0.05)(D)),
        }
    _A_in = _A_setup()

    def _B_setup():
        B, S, D, F, C = 1, 2048, 640, 1728, 1
        return {
            "x": _w((lambda *s: torch.randn(*s, dtype=torch.bfloat16) * 0.05)(B, S, D)),
            "w_r": _w((lambda *s: torch.randn(*s, dtype=torch.bfloat16) * 0.05)(D)),
            "w_gate": _w((lambda *s: torch.randn(*s, dtype=torch.bfloat16) * 0.05)(D, F)),
            "w_up": _w((lambda *s: torch.randn(*s, dtype=torch.bfloat16) * 0.05)(D, F)),
            "w_down": _w((lambda *s: torch.randn(*s, dtype=torch.bfloat16) * 0.05)(F, D)),
        }
    _B_in = _B_setup()

    return {
        "A_u": _A_in["u"],
        "A_log_A_real": _A_in["log_A_real"],
        "A_A_imag": _A_in["A_imag"],
        "A_C_real": _A_in["C_real"],
        "A_C_imag": _A_in["C_imag"],
        "A_log_dt": _A_in["log_dt"],
        "A_D_skip": _A_in["D_skip"],
        "B_x": _B_in["x"],
        "B_w_r": _B_in["w_r"],
        "B_w_gate": _B_in["w_gate"],
        "B_w_up": _B_in["w_up"],
        "B_w_down": _B_in["w_down"],
    }

def reference(A_u, A_log_A_real, A_A_imag, A_C_real, A_C_imag, A_log_dt, A_D_skip, B_x, B_w_r, B_w_gate, B_w_up, B_w_down):
    def _A_ref(u, log_A_real, A_imag, C_real, C_imag, log_dt, D_skip):
        L = u.shape[1]
        dt = torch.exp(log_dt)
        A = -torch.exp(log_A_real) + 1j * A_imag
        C = (C_real + 1j * C_imag) * dt[:, None]
        pos = (lambda x, dt: x.to(dt))(torch.arange(L), log_dt.dtype)
        P = torch.exp((A * dt[:, None])[:, :, None] * pos[None, None, :])
        K = 2.0 * torch.einsum("dn,dnl->dl", C, P).real
        L2 = 2 * L
        u_t = (lambda x, *d: x.permute(*d))(u, 0, 2, 1)
        Kf = (lambda x, *a, **k: torch.fft.rfft(x.float(), *a, **k))(K, L2)
        Uf = (lambda x, *a, **k: torch.fft.rfft(x.float(), *a, **k))(u_t, L2)
        y = (lambda x, *a, **k: torch.fft.irfft(x, *a, **k).to(torch.bfloat16))(Uf * Kf[None, :, :], L2)[:, :, :L]
        y = (lambda x, *d: x.permute(*d))(y, 0, 2, 1)
        return y + u * D_skip[None, None, :]

    def _B_ref(x, w_r, w_gate, w_up, w_down):
        B, S, D = x.shape
        C = 1
        r = x @ w_r
        idx = torch.argsort(-r, axis=-1)[:, :C]
        idx_e = (lambda x, n, axis: torch.repeat_interleave(x, n, dim=axis))(idx.reshape(B, C, 1), D, axis=2)
        x_sel = (lambda x, i, axis: torch.take_along_dim(x, i, dim=axis))(x, idx_e, axis=1)
        g = _silu(x_sel @ w_gate)
        u = x_sel @ w_up
        y = (g * u) @ w_down
        r_sel = _sigmoid((lambda x, i, axis: torch.take_along_dim(x, i, dim=axis))(r, idx, axis=1))
        y = y * r_sel.reshape(B, C, 1)
        b_off = (torch.arange(B) * S).reshape(B, 1)
        flat_idx = (idx + b_off).reshape(B * C)
        zero = (x * 0.0).reshape(B * S, D)
        upd = _scatter_add(zero, flat_idx, y.reshape(B * C, D), axis=0)
        return x + upd.reshape(B, S, D)

    x = A_u
    h = x + _A_ref(_layernorm(x, axis=-1), A_log_A_real, A_A_imag, A_C_real, A_C_imag, A_log_dt, A_D_skip)
    h2 = h + _B_ref(_layernorm(h, axis=-1), B_w_r, B_w_gate, B_w_up, B_w_down)
    return h2
```

```asm
; @launch kernel=k1_kernel grid=(929,1,1) block=(256,1,1) lds=36416
; @launch kernel=k2_kernel grid=(768,1,1) block=(256,1,1) lds=41472
; @launch kernel=kb_kernel grid=(222,1,1) block=(640,1,1) lds=5120
.amdgcn_target "amdgcn-amd-amdhsa--gfx950"
.text
.p2align 8
.globl k1_kernel
.type k1_kernel,@function
k1_kernel:
    s_cmp_ge_u32 s2, 929
    s_cbranch_scc1 K1_END
    s_load_dwordx2 s[6:7], s[0:1], 112
    s_cmp_ge_u32 s2, 640
    s_cbranch_scc1 K1_LN
    s_load_dwordx4 s[8:11], s[0:1], 8
    s_load_dwordx4 s[12:15], s[0:1], 24
    s_load_dwordx2 s[16:17], s[0:1], 40
    s_mov_b32 s29, s2
    s_and_b32 s3, s2, 7
    s_mul_i32 s3, s3, 80
    s_lshr_b32 s2, s2, 3
    s_add_u32 s2, s2, s3
    v_and_b32 v1, 127, v0
    s_lshl_b32 s3, s2, 8
    v_lshl_add_u32 v2, v1, 1, s3
    v_xor_b32 v3, 128, v2
    s_lshl_b32 s4, s2, 1
    v_mov_b32 v4, s4
    v_lshrrev_b32 v5, 6, v0
    s_waitcnt lgkmcnt(0)
    global_load_ushort v10, v2, s[8:9]
    global_load_ushort v11, v2, s[10:11]
    global_load_ushort v12, v2, s[12:13]
    global_load_ushort v13, v2, s[14:15]
    global_load_ushort v14, v3, s[12:13]
    global_load_ushort v15, v3, s[14:15]
    global_load_ushort v16, v4, s[16:17]
    v_readfirstlane_b32 s5, v5
    v_mov_b32 v6, 36352
    v_mov_b32 v7, 0
    ds_write_b32 v6, v7
    s_and_b32 s4, s5, 1
    s_lshl_b32 s4, s4, 8
    s_mov_b32 m0, s4
    s_waitcnt vmcnt(0)
    v_and_b32 v20, 0x7fff, v12
    v_and_b32 v21, 0x7fff, v13
    v_and_b32 v22, 0x7fff, v14
    v_and_b32 v23, 0x7fff, v15
    v_max_u32 v20, v20, v21
    v_max3_u32 v20, v20, v22, v23
    s_nop 1
    v_max_u32_dpp v20, v20, v20 row_ror:8 row_mask:0xf bank_mask:0xf
    s_nop 1
    v_max_u32_dpp v20, v20, v20 row_ror:4 row_mask:0xf bank_mask:0xf
    s_nop 1
    v_max_u32_dpp v20, v20, v20 row_ror:2 row_mask:0xf bank_mask:0xf
    s_nop 1
    v_max_u32_dpp v20, v20, v20 row_ror:1 row_mask:0xf bank_mask:0xf
    s_nop 0
    v_readlane_b32 s20, v20, 0
    v_readlane_b32 s21, v20, 16
    v_readlane_b32 s22, v20, 32
    v_readlane_b32 s23, v20, 48
    s_max_u32 s20, s20, s21
    s_nop 0
    s_max_u32 s22, s22, s23
    s_max_u32 s20, s20, s22
    s_lshr_b32 s20, s20, 7
    s_max_u32 s20, s20, 1
    s_min_u32 s20, s20, 252
    s_lshl_b32 s21, s20, 23
    s_sub_u32 s22, 255, s20
    s_lshl_b32 s22, s22, 23
    v_lshlrev_b32 v10, 16, v10
    v_lshlrev_b32 v11, 16, v11
    v_lshlrev_b32 v12, 16, v12
    v_lshlrev_b32 v13, 16, v13
    v_lshlrev_b32 v16, 16, v16
    v_mul_f32 v16, 0x3fb8aa3b, v16
    v_mul_f32 v10, 0x3fb8aa3b, v10
    v_exp_f32 v16, v16
    v_exp_f32 v10, v10
    v_cvt_pk_bf16_f32 v16, v16, v16
    v_lshlrev_b32 v16, 16, v16
    v_cvt_pk_bf16_f32 v10, v10, v10
    v_lshlrev_b32 v10, 16, v10
    v_mul_f32 v10, v10, v16
    v_mul_f32 v11, v11, v16
    v_mul_f32 v10, 0xbfb8aa3b, v10
    v_mul_f32 v11, 0x3e22f983, v11
    v_mul_f32 v12, s22, v12
    v_mul_f32 v13, s22, v13
    v_mul_f32 v17, s21, v16
    s_cmp_ge_u32 s5, 2
    s_cbranch_scc1 K1_TS1
    v_mul_f32 v20, 0x3f800000, v10
    v_mul_f32 v21, 0x3f800000, v11
    v_exp_f32 v20, v20
    v_fract_f32 v21, v21
    v_cos_f32 v50, v21
    v_sin_f32 v51, v21
    v_mul_f32 v50, v50, v20
    v_mul_f32 v51, v51, v20
    v_mul_f32 v22, 0x41000000, v10
    v_mul_f32 v23, 0x41000000, v11
    v_exp_f32 v22, v22
    v_fract_f32 v23, v23
    v_cos_f32 v52, v23
    v_sin_f32 v53, v23
    v_mul_f32 v52, v52, v22
    v_mul_f32 v53, v53, v22
    v_mul_f32 v24, 0x43000000, v10
    v_mul_f32 v25, 0x43000000, v11
    v_exp_f32 v24, v24
    v_fract_f32 v25, v25
    v_cos_f32 v54, v25
    v_sin_f32 v55, v25
    v_mul_f32 v54, v54, v24
    v_mul_f32 v55, v55, v24
    s_lshl_b32 s4, s2, 2
    v_mov_b32 v9, s4
    s_add_u32 s24, s6, 10485760
    s_addc_u32 s25, s7, 0
    global_store_dword v9, v17, s[24:25]
    v_cvt_pk_f16_f32 v36, v12, -v13
    ds_write_addtid_b32 v36 offset:26112
    v_mov_b32 v30, 0x3c00
    ds_write_addtid_b32 v30 offset:0
    v_cvt_pk_f16_f32 v37, v50, v51
    ds_write_addtid_b32 v37 offset:544
    v_cvt_pk_f16_f32 v38, v54, v55
    ds_write_addtid_b32 v38 offset:4352
    v_pk_mul_f32 v[64:65], v[54:55], v[50:51] op_sel:[0,0] op_sel_hi:[0,1]
    s_nop 0
    v_pk_fma_f32 v[64:65], v[54:55], v[50:51], v[64:65] op_sel:[1,1,0] op_sel_hi:[1,0,1] neg_lo:[1,0,0]
    s_nop 0
    v_cvt_pk_f16_f32 v39, v64, v65
    ds_write_addtid_b32 v39 offset:4896
    v_pk_mul_f32 v[58:59], v[12:13], v[52:53] op_sel:[0,0] op_sel_hi:[0,1]
    s_nop 0
    v_pk_fma_f32 v[58:59], v[12:13], v[52:53], v[58:59] op_sel:[1,1,0] op_sel_hi:[1,0,1] neg_lo:[1,0,0]
    s_nop 0
    v_cvt_pk_f16_f32 v36, v58, -v59
    ds_write_addtid_b32 v36 offset:26656
    v_pk_mul_f32 v[56:57], v[58:59], v[52:53] op_sel:[0,0] op_sel_hi:[0,1]
    s_nop 0
    v_pk_fma_f32 v[56:57], v[58:59], v[52:53], v[56:57] op_sel:[1,1,0] op_sel_hi:[1,0,1] neg_lo:[1,0,0]
    s_nop 0
    v_cvt_pk_f16_f32 v37, v56, -v57
    ds_write_addtid_b32 v37 offset:27200
    v_pk_mul_f32 v[60:61], v[50:51], v[50:51] op_sel:[0,0] op_sel_hi:[0,1]
    s_nop 0
    v_pk_fma_f32 v[60:61], v[50:51], v[50:51], v[60:61] op_sel:[1,1,0] op_sel_hi:[1,0,1] neg_lo:[1,0,0]
    s_nop 0
    v_cvt_pk_f16_f32 v38, v60, v61
    ds_write_addtid_b32 v38 offset:1088
    v_pk_mul_f32 v[64:65], v[54:55], v[60:61] op_sel:[0,0] op_sel_hi:[0,1]
    s_nop 0
    v_pk_fma_f32 v[64:65], v[54:55], v[60:61], v[64:65] op_sel:[1,1,0] op_sel_hi:[1,0,1] neg_lo:[1,0,0]
    s_nop 0
    v_cvt_pk_f16_f32 v39, v64, v65
    ds_write_addtid_b32 v39 offset:5440
    v_pk_mul_f32 v[58:59], v[56:57], v[52:53] op_sel:[0,0] op_sel_hi:[0,1]
    s_nop 0
    v_pk_fma_f32 v[58:59], v[56:57], v[52:53], v[58:59] op_sel:[1,1,0] op_sel_hi:[1,0,1] neg_lo:[1,0,0]
    s_nop 0
    v_cvt_pk_f16_f32 v36, v58, -v59
    ds_write_addtid_b32 v36 offset:27744
    v_pk_mul_f32 v[62:63], v[60:61], v[50:51] op_sel:[0,0] op_sel_hi:[0,1]
    s_nop 0
    v_pk_fma_f32 v[62:63], v[60:61], v[50:51], v[62:63] op_sel:[1,1,0] op_sel_hi:[1,0,1] neg_lo:[1,0,0]
    s_nop 0
    v_cvt_pk_f16_f32 v37, v62, v63
    ds_write_addtid_b32 v37 offset:1632
    v_pk_mul_f32 v[66:67], v[54:55], v[62:63] op_sel:[0,0] op_sel_hi:[0,1]
    s_nop 0
    v_pk_fma_f32 v[66:67], v[54:55], v[62:63], v[66:67] op_sel:[1,1,0] op_sel_hi:[1,0,1] neg_lo:[1,0,0]
    s_nop 0
    v_cvt_pk_f16_f32 v38, v66, v67
    ds_write_addtid_b32 v38 offset:5984
    v_pk_mul_f32 v[56:57], v[58:59], v[52:53] op_sel:[0,0] op_sel_hi:[0,1]
    s_nop 0
    v_pk_fma_f32 v[56:57], v[58:59], v[52:53], v[56:57] op_sel:[1,1,0] op_sel_hi:[1,0,1] neg_lo:[1,0,0]
    s_nop 0
    v_cvt_pk_f16_f32 v39, v56, -v57
    ds_write_addtid_b32 v39 offset:28288
    v_pk_mul_f32 v[60:61], v[62:63], v[50:51] op_sel:[0,0] op_sel_hi:[0,1]
    s_nop 0
    v_pk_fma_f32 v[60:61], v[62:63], v[50:51], v[60:61] op_sel:[1,1,0] op_sel_hi:[1,0,1] neg_lo:[1,0,0]
    s_nop 0
    v_cvt_pk_f16_f32 v36, v60, v61
    ds_write_addtid_b32 v36 offset:2176
    v_pk_mul_f32 v[64:65], v[54:55], v[60:61] op_sel:[0,0] op_sel_hi:[0,1]
    s_nop 0
    v_pk_fma_f32 v[64:65], v[54:55], v[60:61], v[64:65] op_sel:[1,1,0] op_sel_hi:[1,0,1] neg_lo:[1,0,0]
    s_nop 0
    v_cvt_pk_f16_f32 v37, v64, v65
    ds_write_addtid_b32 v37 offset:6528
    v_pk_mul_f32 v[58:59], v[56:57], v[52:53] op_sel:[0,0] op_sel_hi:[0,1]
    s_nop 0
    v_pk_fma_f32 v[58:59], v[56:57], v[52:53], v[58:59] op_sel:[1,1,0] op_sel_hi:[1,0,1] neg_lo:[1,0,0]
    s_nop 0
    v_cvt_pk_f16_f32 v38, v58, -v59
    ds_write_addtid_b32 v38 offset:28832
    v_pk_mul_f32 v[62:63], v[60:61], v[50:51] op_sel:[0,0] op_sel_hi:[0,1]
    s_nop 0
    v_pk_fma_f32 v[62:63], v[60:61], v[50:51], v[62:63] op_sel:[1,1,0] op_sel_hi:[1,0,1] neg_lo:[1,0,0]
    s_nop 0
    v_cvt_pk_f16_f32 v39, v62, v63
    ds_write_addtid_b32 v39 offset:2720
    v_pk_mul_f32 v[66:67], v[54:55], v[62:63] op_sel:[0,0] op_sel_hi:[0,1]
    s_nop 0
    v_pk_fma_f32 v[66:67], v[54:55], v[62:63], v[66:67] op_sel:[1,1,0] op_sel_hi:[1,0,1] neg_lo:[1,0,0]
    s_nop 0
    v_cvt_pk_f16_f32 v36, v66, v67
    ds_write_addtid_b32 v36 offset:7072
    v_pk_mul_f32 v[56:57], v[58:59], v[52:53] op_sel:[0,0] op_sel_hi:[0,1]
    s_nop 0
    v_pk_fma_f32 v[56:57], v[58:59], v[52:53], v[56:57] op_sel:[1,1,0] op_sel_hi:[1,0,1] neg_lo:[1,0,0]
    s_nop 0
    v_cvt_pk_f16_f32 v37, v56, -v57
    ds_write_addtid_b32 v37 offset:29376
    v_pk_mul_f32 v[60:61], v[62:63], v[50:51] op_sel:[0,0] op_sel_hi:[0,1]
    s_nop 0
    v_pk_fma_f32 v[60:61], v[62:63], v[50:51], v[60:61] op_sel:[1,1,0] op_sel_hi:[1,0,1] neg_lo:[1,0,0]
    s_nop 0
    v_cvt_pk_f16_f32 v38, v60, v61
    ds_write_addtid_b32 v38 offset:3264
    v_pk_mul_f32 v[64:65], v[54:55], v[60:61] op_sel:[0,0] op_sel_hi:[0,1]
    s_nop 0
    v_pk_fma_f32 v[64:65], v[54:55], v[60:61], v[64:65] op_sel:[1,1,0] op_sel_hi:[1,0,1] neg_lo:[1,0,0]
    s_nop 0
    v_cvt_pk_f16_f32 v39, v64, v65
    ds_write_addtid_b32 v39 offset:7616
    v_pk_mul_f32 v[58:59], v[56:57], v[52:53] op_sel:[0,0] op_sel_hi:[0,1]
    s_nop 0
    v_pk_fma_f32 v[58:59], v[56:57], v[52:53], v[58:59] op_sel:[1,1,0] op_sel_hi:[1,0,1] neg_lo:[1,0,0]
    s_nop 0
    v_cvt_pk_f16_f32 v36, v58, -v59
    ds_write_addtid_b32 v36 offset:29920
    v_pk_mul_f32 v[62:63], v[60:61], v[50:51] op_sel:[0,0] op_sel_hi:[0,1]
    s_nop 0
    v_pk_fma_f32 v[62:63], v[60:61], v[50:51], v[62:63] op_sel:[1,1,0] op_sel_hi:[1,0,1] neg_lo:[1,0,0]
    s_nop 0
    v_cvt_pk_f16_f32 v37, v62, v63
    ds_write_addtid_b32 v37 offset:3808
    v_pk_mul_f32 v[66:67], v[54:55], v[62:63] op_sel:[0,0] op_sel_hi:[0,1]
    s_nop 0
    v_pk_fma_f32 v[66:67], v[54:55], v[62:63], v[66:67] op_sel:[1,1,0] op_sel_hi:[1,0,1] neg_lo:[1,0,0]
    s_nop 0
    v_cvt_pk_f16_f32 v38, v66, v67
    ds_write_addtid_b32 v38 offset:8160
    v_pk_mul_f32 v[56:57], v[58:59], v[52:53] op_sel:[0,0] op_sel_hi:[0,1]
    s_nop 0
    v_pk_fma_f32 v[56:57], v[58:59], v[52:53], v[56:57] op_sel:[1,1,0] op_sel_hi:[1,0,1] neg_lo:[1,0,0]
    s_nop 0
    v_cvt_pk_f16_f32 v39, v56, -v57
    ds_write_addtid_b32 v39 offset:30464
    v_pk_mul_f32 v[58:59], v[56:57], v[52:53] op_sel:[0,0] op_sel_hi:[0,1]
    s_nop 0
    v_pk_fma_f32 v[58:59], v[56:57], v[52:53], v[58:59] op_sel:[1,1,0] op_sel_hi:[1,0,1] neg_lo:[1,0,0]
    s_nop 0
    v_cvt_pk_f16_f32 v36, v58, -v59
    ds_write_addtid_b32 v36 offset:31008
    v_pk_mul_f32 v[56:57], v[58:59], v[52:53] op_sel:[0,0] op_sel_hi:[0,1]
    s_nop 0
    v_pk_fma_f32 v[56:57], v[58:59], v[52:53], v[56:57] op_sel:[1,1,0] op_sel_hi:[1,0,1] neg_lo:[1,0,0]
    s_nop 0
    v_cvt_pk_f16_f32 v37, v56, -v57
    ds_write_addtid_b32 v37 offset:31552
    v_pk_mul_f32 v[58:59], v[56:57], v[52:53] op_sel:[0,0] op_sel_hi:[0,1]
    s_nop 0
    v_pk_fma_f32 v[58:59], v[56:57], v[52:53], v[58:59] op_sel:[1,1,0] op_sel_hi:[1,0,1] neg_lo:[1,0,0]
    s_nop 0
    v_cvt_pk_f16_f32 v38, v58, -v59
    ds_write_addtid_b32 v38 offset:32096
    v_pk_mul_f32 v[56:57], v[58:59], v[52:53] op_sel:[0,0] op_sel_hi:[0,1]
    s_nop 0
    v_pk_fma_f32 v[56:57], v[58:59], v[52:53], v[56:57] op_sel:[1,1,0] op_sel_hi:[1,0,1] neg_lo:[1,0,0]
    s_nop 0
    v_cvt_pk_f16_f32 v39, v56, -v57
    ds_write_addtid_b32 v39 offset:32640
    v_pk_mul_f32 v[58:59], v[56:57], v[52:53] op_sel:[0,0] op_sel_hi:[0,1]
    s_nop 0
    v_pk_fma_f32 v[58:59], v[56:57], v[52:53], v[58:59] op_sel:[1,1,0] op_sel_hi:[1,0,1] neg_lo:[1,0,0]
    s_nop 0
    v_cvt_pk_f16_f32 v36, v58, -v59
    ds_write_addtid_b32 v36 offset:33184
    v_pk_mul_f32 v[56:57], v[58:59], v[52:53] op_sel:[0,0] op_sel_hi:[0,1]
    s_nop 0
    v_pk_fma_f32 v[56:57], v[58:59], v[52:53], v[56:57] op_sel:[1,1,0] op_sel_hi:[1,0,1] neg_lo:[1,0,0]
    s_nop 0
    v_cvt_pk_f16_f32 v37, v56, -v57
    ds_write_addtid_b32 v37 offset:33728
    v_pk_mul_f32 v[58:59], v[56:57], v[52:53] op_sel:[0,0] op_sel_hi:[0,1]
    s_nop 0
    v_pk_fma_f32 v[58:59], v[56:57], v[52:53], v[58:59] op_sel:[1,1,0] op_sel_hi:[1,0,1] neg_lo:[1,0,0]
    s_nop 0
    v_cvt_pk_f16_f32 v38, v58, -v59
    ds_write_addtid_b32 v38 offset:34272
    s_branch K1_JOIN
K1_TS1:
    v_mul_f32 v20, 0x43000000, v10
    v_mul_f32 v21, 0x43000000, v11
    v_exp_f32 v20, v20
    v_fract_f32 v21, v21
    v_cos_f32 v50, v21
    v_sin_f32 v51, v21
    v_mul_f32 v50, v50, v20
    v_mul_f32 v51, v51, v20
    v_mul_f32 v22, 0x40000000, v10
    v_mul_f32 v23, 0x40000000, v11
    v_exp_f32 v22, v22
    v_fract_f32 v23, v23
    v_cos_f32 v52, v23
    v_sin_f32 v53, v23
    v_mul_f32 v52, v52, v22
    v_mul_f32 v53, v53, v22
    v_mul_f32 v24, 0x40800000, v10
    v_mul_f32 v25, 0x40800000, v11
    v_exp_f32 v24, v24
    v_fract_f32 v25, v25
    v_cos_f32 v54, v25
    v_sin_f32 v55, v25
    v_mul_f32 v54, v54, v24
    v_mul_f32 v55, v55, v24
    v_pk_mul_f32 v[56:57], v[52:53], v[54:55] op_sel:[0,0] op_sel_hi:[0,1]
    s_nop 0
    v_pk_fma_f32 v[56:57], v[52:53], v[54:55], v[56:57] op_sel:[1,1,0] op_sel_hi:[1,0,1] neg_lo:[1,0,0]
    v_pk_mul_f32 v[58:59], v[50:51], v[50:51] op_sel:[0,0] op_sel_hi:[0,1]
    s_nop 0
    v_pk_fma_f32 v[58:59], v[50:51], v[50:51], v[58:59] op_sel:[1,1,0] op_sel_hi:[1,0,1] neg_lo:[1,0,0]
    s_nop 0
    v_cvt_pk_f16_f32 v39, v58, v59
    ds_write_addtid_b32 v39 offset:8704
    v_pk_mul_f32 v[62:63], v[58:59], v[52:53] op_sel:[0,0] op_sel_hi:[0,1]
    s_nop 0
    v_pk_fma_f32 v[62:63], v[58:59], v[52:53], v[62:63] op_sel:[1,1,0] op_sel_hi:[1,0,1] neg_lo:[1,0,0]
    s_nop 0
    v_cvt_pk_f16_f32 v36, v62, v63
    ds_write_addtid_b32 v36 offset:9248
    v_pk_mul_f32 v[64:65], v[58:59], v[54:55] op_sel:[0,0] op_sel_hi:[0,1]
    s_nop 0
    v_pk_fma_f32 v[64:65], v[58:59], v[54:55], v[64:65] op_sel:[1,1,0] op_sel_hi:[1,0,1] neg_lo:[1,0,0]
    s_nop 0
    v_cvt_pk_f16_f32 v37, v64, v65
    ds_write_addtid_b32 v37 offset:9792
    v_pk_mul_f32 v[62:63], v[58:59], v[56:57] op_sel:[0,0] op_sel_hi:[0,1]
    s_nop 0
    v_pk_fma_f32 v[62:63], v[58:59], v[56:57], v[62:63] op_sel:[1,1,0] op_sel_hi:[1,0,1] neg_lo:[1,0,0]
    s_nop 0
    v_cvt_pk_f16_f32 v38, v62, v63
    ds_write_addtid_b32 v38 offset:10336
    v_pk_mul_f32 v[60:61], v[58:59], v[50:51] op_sel:[0,0] op_sel_hi:[0,1]
    s_nop 0
    v_pk_fma_f32 v[60:61], v[58:59], v[50:51], v[60:61] op_sel:[1,1,0] op_sel_hi:[1,0,1] neg_lo:[1,0,0]
    s_nop 0
    v_cvt_pk_f16_f32 v39, v60, v61
    ds_write_addtid_b32 v39 offset:10880
    v_pk_mul_f32 v[62:63], v[60:61], v[52:53] op_sel:[0,0] op_sel_hi:[0,1]
    s_nop 0
    v_pk_fma_f32 v[62:63], v[60:61], v[52:53], v[62:63] op_sel:[1,1,0] op_sel_hi:[1,0,1] neg_lo:[1,0,0]
    s_nop 0
    v_cvt_pk_f16_f32 v36, v62, v63
    ds_write_addtid_b32 v36 offset:11424
    v_pk_mul_f32 v[64:65], v[60:61], v[54:55] op_sel:[0,0] op_sel_hi:[0,1]
    s_nop 0
    v_pk_fma_f32 v[64:65], v[60:61], v[54:55], v[64:65] op_sel:[1,1,0] op_sel_hi:[1,0,1] neg_lo:[1,0,0]
    s_nop 0
    v_cvt_pk_f16_f32 v37, v64, v65
    ds_write_addtid_b32 v37 offset:11968
    v_pk_mul_f32 v[62:63], v[60:61], v[56:57] op_sel:[0,0] op_sel_hi:[0,1]
    s_nop 0
    v_pk_fma_f32 v[62:63], v[60:61], v[56:57], v[62:63] op_sel:[1,1,0] op_sel_hi:[1,0,1] neg_lo:[1,0,0]
    s_nop 0
    v_cvt_pk_f16_f32 v38, v62, v63
    ds_write_addtid_b32 v38 offset:12512
    v_pk_mul_f32 v[58:59], v[60:61], v[50:51] op_sel:[0,0] op_sel_hi:[0,1]
    s_nop 0
    v_pk_fma_f32 v[58:59], v[60:61], v[50:51], v[58:59] op_sel:[1,1,0] op_sel_hi:[1,0,1] neg_lo:[1,0,0]
    s_nop 0
    v_cvt_pk_f16_f32 v39, v58, v59
    ds_write_addtid_b32 v39 offset:13056
    v_pk_mul_f32 v[62:63], v[58:59], v[54:55] op_sel:[0,0] op_sel_hi:[0,1]
    s_nop 0
    v_pk_fma_f32 v[62:63], v[58:59], v[54:55], v[62:63] op_sel:[1,1,0] op_sel_hi:[1,0,1] neg_lo:[1,0,0]
    s_nop 0
    v_cvt_pk_f16_f32 v36, v62, v63
    ds_write_addtid_b32 v36 offset:13600
    v_pk_mul_f32 v[60:61], v[58:59], v[50:51] op_sel:[0,0] op_sel_hi:[0,1]
    s_nop 0
    v_pk_fma_f32 v[60:61], v[58:59], v[50:51], v[60:61] op_sel:[1,1,0] op_sel_hi:[1,0,1] neg_lo:[1,0,0]
    s_nop 0
    v_cvt_pk_f16_f32 v37, v60, v61
    ds_write_addtid_b32 v37 offset:14144
    v_pk_mul_f32 v[64:65], v[60:61], v[54:55] op_sel:[0,0] op_sel_hi:[0,1]
    s_nop 0
    v_pk_fma_f32 v[64:65], v[60:61], v[54:55], v[64:65] op_sel:[1,1,0] op_sel_hi:[1,0,1] neg_lo:[1,0,0]
    s_nop 0
    v_cvt_pk_f16_f32 v38, v64, v65
    ds_write_addtid_b32 v38 offset:14688
    v_pk_mul_f32 v[58:59], v[60:61], v[50:51] op_sel:[0,0] op_sel_hi:[0,1]
    s_nop 0
    v_pk_fma_f32 v[58:59], v[60:61], v[50:51], v[58:59] op_sel:[1,1,0] op_sel_hi:[1,0,1] neg_lo:[1,0,0]
    s_nop 0
    v_cvt_pk_f16_f32 v39, v58, v59
    ds_write_addtid_b32 v39 offset:15232
    v_pk_mul_f32 v[62:63], v[58:59], v[54:55] op_sel:[0,0] op_sel_hi:[0,1]
    s_nop 0
    v_pk_fma_f32 v[62:63], v[58:59], v[54:55], v[62:63] op_sel:[1,1,0] op_sel_hi:[1,0,1] neg_lo:[1,0,0]
    s_nop 0
    v_cvt_pk_f16_f32 v36, v62, v63
    ds_write_addtid_b32 v36 offset:15776
    v_pk_mul_f32 v[60:61], v[58:59], v[50:51] op_sel:[0,0] op_sel_hi:[0,1]
    s_nop 0
    v_pk_fma_f32 v[60:61], v[58:59], v[50:51], v[60:61] op_sel:[1,1,0] op_sel_hi:[1,0,1] neg_lo:[1,0,0]
    s_nop 0
    v_cvt_pk_f16_f32 v37, v60, v61
    ds_write_addtid_b32 v37 offset:16320
    v_pk_mul_f32 v[64:65], v[60:61], v[54:55] op_sel:[0,0] op_sel_hi:[0,1]
    s_nop 0
    v_pk_fma_f32 v[64:65], v[60:61], v[54:55], v[64:65] op_sel:[1,1,0] op_sel_hi:[1,0,1] neg_lo:[1,0,0]
    s_nop 0
    v_cvt_pk_f16_f32 v38, v64, v65
    ds_write_addtid_b32 v38 offset:16864
    v_pk_mul_f32 v[58:59], v[60:61], v[50:51] op_sel:[0,0] op_sel_hi:[0,1]
    s_nop 0
    v_pk_fma_f32 v[58:59], v[60:61], v[50:51], v[58:59] op_sel:[1,1,0] op_sel_hi:[1,0,1] neg_lo:[1,0,0]
    s_nop 0
    v_cvt_pk_f16_f32 v39, v58, v59
    ds_write_addtid_b32 v39 offset:17408
    v_pk_mul_f32 v[60:61], v[58:59], v[50:51] op_sel:[0,0] op_sel_hi:[0,1]
    s_nop 0
    v_pk_fma_f32 v[60:61], v[58:59], v[50:51], v[60:61] op_sel:[1,1,0] op_sel_hi:[1,0,1] neg_lo:[1,0,0]
    s_nop 0
    v_cvt_pk_f16_f32 v36, v60, v61
    ds_write_addtid_b32 v36 offset:17952
    v_pk_mul_f32 v[58:59], v[60:61], v[50:51] op_sel:[0,0] op_sel_hi:[0,1]
    s_nop 0
    v_pk_fma_f32 v[58:59], v[60:61], v[50:51], v[58:59] op_sel:[1,1,0] op_sel_hi:[1,0,1] neg_lo:[1,0,0]
    s_nop 0
    v_cvt_pk_f16_f32 v37, v58, v59
    ds_write_addtid_b32 v37 offset:18496
    v_pk_mul_f32 v[60:61], v[58:59], v[50:51] op_sel:[0,0] op_sel_hi:[0,1]
    s_nop 0
    v_pk_fma_f32 v[60:61], v[58:59], v[50:51], v[60:61] op_sel:[1,1,0] op_sel_hi:[1,0,1] neg_lo:[1,0,0]
    s_nop 0
    v_cvt_pk_f16_f32 v38, v60, v61
    ds_write_addtid_b32 v38 offset:19040
    v_pk_mul_f32 v[58:59], v[60:61], v[50:51] op_sel:[0,0] op_sel_hi:[0,1]
    s_nop 0
    v_pk_fma_f32 v[58:59], v[60:61], v[50:51], v[58:59] op_sel:[1,1,0] op_sel_hi:[1,0,1] neg_lo:[1,0,0]
    s_nop 0
    v_cvt_pk_f16_f32 v39, v58, v59
    ds_write_addtid_b32 v39 offset:19584
    v_pk_mul_f32 v[60:61], v[58:59], v[50:51] op_sel:[0,0] op_sel_hi:[0,1]
    s_nop 0
    v_pk_fma_f32 v[60:61], v[58:59], v[50:51], v[60:61] op_sel:[1,1,0] op_sel_hi:[1,0,1] neg_lo:[1,0,0]
    s_nop 0
    v_cvt_pk_f16_f32 v36, v60, v61
    ds_write_addtid_b32 v36 offset:20128
    v_pk_mul_f32 v[58:59], v[60:61], v[50:51] op_sel:[0,0] op_sel_hi:[0,1]
    s_nop 0
    v_pk_fma_f32 v[58:59], v[60:61], v[50:51], v[58:59] op_sel:[1,1,0] op_sel_hi:[1,0,1] neg_lo:[1,0,0]
    s_nop 0
    v_cvt_pk_f16_f32 v37, v58, v59
    ds_write_addtid_b32 v37 offset:20672
    v_pk_mul_f32 v[60:61], v[58:59], v[50:51] op_sel:[0,0] op_sel_hi:[0,1]
    s_nop 0
    v_pk_fma_f32 v[60:61], v[58:59], v[50:51], v[60:61] op_sel:[1,1,0] op_sel_hi:[1,0,1] neg_lo:[1,0,0]
    s_nop 0
    v_cvt_pk_f16_f32 v38, v60, v61
    ds_write_addtid_b32 v38 offset:21216
    v_pk_mul_f32 v[58:59], v[60:61], v[50:51] op_sel:[0,0] op_sel_hi:[0,1]
    s_nop 0
    v_pk_fma_f32 v[58:59], v[60:61], v[50:51], v[58:59] op_sel:[1,1,0] op_sel_hi:[1,0,1] neg_lo:[1,0,0]
    s_nop 0
    v_cvt_pk_f16_f32 v39, v58, v59
    ds_write_addtid_b32 v39 offset:21760
K1_JOIN:
    v_and_b32 v20, 15, v0
    v_bfe_u32 v21, v0, 4, 2
    v_mul_u32_u24 v22, 544, v20
    v_lshl_add_u32 v22, v21, 4, v22
    s_mul_i32 s8, s5, 8704
    v_add_u32 v23, s8, v22
    s_waitcnt lgkmcnt(0)
    s_barrier
    s_cmp_eq_u32 s5, 3
    s_cbranch_scc1 K1_EXP
    ds_read_b128 v[50:53], v23 offset:0
    ds_read_b128 v[54:57], v22 offset:26112
    ds_read_b128 v[58:61], v23 offset:64
    ds_read_b128 v[62:65], v22 offset:26176
    ds_read_b128 v[66:69], v23 offset:128
    ds_read_b128 v[70:73], v22 offset:26240
    ds_read_b128 v[74:77], v23 offset:192
    ds_read_b128 v[78:81], v22 offset:26304
    s_waitcnt lgkmcnt(6)
    v_mfma_f32_16x16x32_f16 v[28:31], v[50:53], v[54:57], 0
    ds_read_b128 v[50:53], v23 offset:256
    ds_read_b128 v[54:57], v22 offset:26368
    s_waitcnt lgkmcnt(6)
    v_mfma_f32_16x16x32_f16 v[28:31], v[58:61], v[62:65], v[28:31]
    ds_read_b128 v[58:61], v23 offset:320
    ds_read_b128 v[62:65], v22 offset:26432
    s_waitcnt lgkmcnt(6)
    v_mfma_f32_16x16x32_f16 v[28:31], v[66:69], v[70:73], v[28:31]
    ds_read_b128 v[66:69], v23 offset:384
    ds_read_b128 v[70:73], v22 offset:26496
    s_waitcnt lgkmcnt(6)
    v_mfma_f32_16x16x32_f16 v[28:31], v[74:77], v[78:81], v[28:31]
    ds_read_b128 v[74:77], v23 offset:448
    ds_read_b128 v[78:81], v22 offset:26560
    s_waitcnt lgkmcnt(6)
    v_mfma_f32_16x16x32_f16 v[28:31], v[50:53], v[54:57], v[28:31]
    s_waitcnt lgkmcnt(4)
    v_mfma_f32_16x16x32_f16 v[28:31], v[58:61], v[62:65], v[28:31]
    s_waitcnt lgkmcnt(2)
    v_mfma_f32_16x16x32_f16 v[28:31], v[66:69], v[70:73], v[28:31]
    s_waitcnt lgkmcnt(0)
    v_mfma_f32_16x16x32_f16 v[28:31], v[74:77], v[78:81], v[28:31]
    s_nop 7
    v_cvt_pk_f16_f32 v32, v28, v29
    v_cvt_pk_f16_f32 v33, v30, v31
    s_cmp_eq_u32 s5, 1
    s_cbranch_scc1 K1_T1
    s_cmp_eq_u32 s5, 2
    s_cbranch_scc1 K1_T2
    v_lshrrev_b32 v24, 1, v21
    v_and_b32 v25, 1, v21
    v_lshlrev_b32 v24, 8, v24
    v_lshl_add_u32 v24, v25, 3, v24
    v_lshl_add_u32 v24, v20, 4, v24
    ds_write_b64 v24, v[32:33] offset:34816
    s_branch K1_EXP
K1_T1:
    v_lshlrev_b32 v24, 7, v21
    v_lshl_add_u32 v25, v20, 3, v24
    v_lshl_add_u32 v26, v20, 2, v24
    v_cmp_gt_u32 vcc, 2, v21
    s_nop 1
    v_cndmask_b32 v24, v26, v25, vcc
    v_add_u32 v25, 4, v24
    v_add_u32 v26, 64, v24
    v_cndmask_b32 v25, v26, v25, vcc
    ds_write_b32 v24, v32 offset:35328
    ds_write_b32 v25, v33 offset:35328
    s_branch K1_EXP
K1_T2:
    v_lshlrev_b32 v24, 7, v21
    v_lshl_add_u32 v24, v20, 1, v24
    ds_write_b16 v24, v32 offset:35840
    ds_write_b16_d16_hi v24, v32 offset:35872
    ds_write_b16 v24, v33 offset:35904
    ds_write_b16_d16_hi v24, v33 offset:35936
K1_EXP:
    s_waitcnt lgkmcnt(0)
    s_barrier
    v_cmp_gt_u32 vcc, 96, v0
    s_nop 1
    s_and_saveexec_b64 s[10:11], vcc
    s_cbranch_execz K1_KEND
    v_lshlrev_b32 v20, 4, v0
    ds_read_b128 v[50:53], v20 offset:34816
    s_mul_i32 s4, s2, 1536
    s_add_u32 s4, s4, 2621440
    v_add_u32 v20, s4, v20
    s_waitcnt lgkmcnt(0)
    global_store_dwordx4 v20, v[50:53], s[6:7] sc1
K1_KEND:
    s_mov_b32 s2, s29
    s_endpgm
K1_LN:
    s_load_dwordx2 s[4:5], s[0:1], 0
    v_and_b32 v1, 15, v0
    v_bfe_u32 v2, v0, 4, 2
    v_lshrrev_b32 v3, 6, v0
    s_cmp_ge_u32 s2, 928
    s_cbranch_scc1 K1_EA
    s_cmp_ge_u32 s2, 800
    s_cbranch_scc1 K1_ST
    s_sub_u32 s3, s2, 640
    s_mul_i32 s8, s3, 0x3334
    s_lshr_b32 s8, s8, 16
    s_mul_i32 s9, s8, 5
    s_sub_u32 s9, s3, s9
    s_lshl_b32 s8, s8, 6
    s_lshl_b32 s9, s9, 7
    v_lshrrev_b32 v5, 2, v1
    v_and_b32 v6, 3, v1
    v_lshl_add_u32 v5, v5, 3, v6
    v_add_u32 v5, s8, v5
    v_mul_u32_u24 v5, 1280, v5
    v_lshl_add_u32 v6, v3, 5, s9
    v_lshl_add_u32 v5, v6, 1, v5
    v_lshl_add_u32 v5, v2, 4, v5
    v_add_u32 v7, 40960, v5
    s_waitcnt lgkmcnt(0)
    global_load_dwordx4 v[16:19], v5, s[4:5]
    global_load_dwordx4 v[24:27], v7, s[4:5]
    v_add_u32 v5, 5120, v5
    v_add_u32 v7, 5120, v7
    global_load_dwordx4 v[20:23], v5, s[4:5]
    global_load_dwordx4 v[28:31], v7, s[4:5]
    v_lshlrev_b32 v12, 3, v2
    v_sub_u32 v12, v1, v12
    v_add_u32 v13, 16, v12
    v_and_b32 v14, 1, v1
    v_lshlrev_b32 v14, 4, v14
    v_mov_b32 v15, 0x3f80
    v_lshlrev_b32 v14, v14, v15
    v_ashrrev_i32 v12, 1, v12
    v_ashrrev_i32 v13, 1, v13
    v_cmp_eq_u32 vcc, 0, v12
    s_nop 1
    v_cndmask_b32 v48, 0, v14, vcc
    v_cmp_eq_u32 vcc, 0, v13
    s_nop 1
    v_cndmask_b32 v52, 0, v14, vcc
    v_cmp_eq_u32 vcc, 1, v12
    s_nop 1
    v_cndmask_b32 v49, 0, v14, vcc
    v_cmp_eq_u32 vcc, 1, v13
    s_nop 1
    v_cndmask_b32 v53, 0, v14, vcc
    v_cmp_eq_u32 vcc, 2, v12
    s_nop 1
    v_cndmask_b32 v50, 0, v14, vcc
    v_cmp_eq_u32 vcc, 2, v13
    s_nop 1
    v_cndmask_b32 v54, 0, v14, vcc
    v_cmp_eq_u32 vcc, 3, v12
    s_nop 1
    v_cndmask_b32 v51, 0, v14, vcc
    v_cmp_eq_u32 vcc, 3, v13
    s_nop 1
    v_cndmask_b32 v55, 0, v14, vcc
    v_add_u32 v9, v6, v1
    v_lshlrev_b32 v9, 12, v9
    v_lshl_add_u32 v9, v2, 4, v9
    s_lshl_b32 s9, s8, 1
    v_add_u32 v9, s9, v9
    v_add_u32 v10, 65536, v9
    s_mov_b32 s10, 0x07060302
    s_add_u32 s12, s6, 0
    s_addc_u32 s13, s7, 0
    s_waitcnt vmcnt(1)
    v_mfma_f32_16x16x32_bf16 v[56:59], v[16:19], v[48:51], 0
    v_mfma_f32_16x16x32_bf16 v[60:63], v[20:23], v[48:51], 0
    v_mfma_f32_16x16x32_bf16 v[64:67], v[16:19], v[52:55], 0
    v_mfma_f32_16x16x32_bf16 v[68:71], v[20:23], v[52:55], 0
    s_waitcnt vmcnt(0)
    v_mfma_f32_16x16x32_bf16 v[72:75], v[24:27], v[48:51], 0
    v_mfma_f32_16x16x32_bf16 v[76:79], v[28:31], v[48:51], 0
    v_mfma_f32_16x16x32_bf16 v[80:83], v[24:27], v[52:55], 0
    v_mfma_f32_16x16x32_bf16 v[84:87], v[28:31], v[52:55], 0
    v_perm_b32 v32, v57, v56, s10
    v_perm_b32 v33, v59, v58, s10
    v_perm_b32 v34, v61, v60, s10
    v_perm_b32 v35, v63, v62, s10
    global_store_dwordx4 v9, v[32:35], s[12:13] offset:0 sc1
    v_perm_b32 v36, v65, v64, s10
    v_perm_b32 v37, v67, v66, s10
    v_perm_b32 v38, v69, v68, s10
    v_perm_b32 v39, v71, v70, s10
    global_store_dwordx4 v10, v[36:39], s[12:13] offset:0 sc1
    v_perm_b32 v40, v73, v72, s10
    v_perm_b32 v41, v75, v74, s10
    v_perm_b32 v42, v77, v76, s10
    v_perm_b32 v43, v79, v78, s10
    global_store_dwordx4 v9, v[40:43], s[12:13] offset:64 sc1
    v_perm_b32 v44, v81, v80, s10
    v_perm_b32 v45, v83, v82, s10
    v_perm_b32 v46, v85, v84, s10
    v_perm_b32 v47, v87, v86, s10
    global_store_dwordx4 v10, v[44:47], s[12:13] offset:64 sc1
    s_endpgm
K1_ST:
    s_sub_u32 s8, s2, 800
    s_lshl_b32 s8, s8, 4
    v_add_u32 v4, s8, v1
    v_mul_u32_u24 v4, 1280, v4
    v_mul_u32_u24 v5, 320, v3
    v_add_u32 v4, v4, v5
    v_lshl_add_u32 v4, v2, 4, v4
    s_waitcnt lgkmcnt(0)
    global_load_dwordx4 v[16:19], v4, s[4:5] offset:0
    global_load_dwordx4 v[20:23], v4, s[4:5] offset:64
    global_load_dwordx4 v[24:27], v4, s[4:5] offset:128
    global_load_dwordx4 v[28:31], v4, s[4:5] offset:192
    global_load_dwordx4 v[32:35], v4, s[4:5] offset:256
    v_mov_b32 v36, 0x3f803f80
    v_mov_b32 v37, v36
    v_mov_b32 v38, v36
    v_mov_b32 v39, v36
    v_lshlrev_b32 v10, 5, v1
    v_lshl_add_u32 v11, v3, 2, v10
    v_and_b32 v12, 3, v1
    v_lshrrev_b32 v13, 2, v1
    v_add_u32 v9, s8, v0
    v_lshlrev_b32 v9, 2, v9
    s_add_u32 s12, s6, 10878976
    s_addc_u32 s13, s7, 0
    s_waitcnt vmcnt(4)
    v_mfma_f32_16x16x32_bf16 v[40:43], v[16:19], v[16:19], 0
    v_mfma_f32_16x16x32_bf16 v[44:47], v[36:39], v[16:19], 0
    s_waitcnt vmcnt(3)
    v_mfma_f32_16x16x32_bf16 v[40:43], v[20:23], v[20:23], v[40:43]
    v_mfma_f32_16x16x32_bf16 v[44:47], v[36:39], v[20:23], v[44:47]
    s_waitcnt vmcnt(2)
    v_mfma_f32_16x16x32_bf16 v[40:43], v[24:27], v[24:27], v[40:43]
    v_mfma_f32_16x16x32_bf16 v[44:47], v[36:39], v[24:27], v[44:47]
    s_waitcnt vmcnt(1)
    v_mfma_f32_16x16x32_bf16 v[40:43], v[28:31], v[28:31], v[40:43]
    v_mfma_f32_16x16x32_bf16 v[44:47], v[36:39], v[28:31], v[44:47]
    s_waitcnt vmcnt(0)
    v_mfma_f32_16x16x32_bf16 v[40:43], v[32:35], v[32:35], v[40:43]
    v_mfma_f32_16x16x32_bf16 v[44:47], v[36:39], v[32:35], v[44:47]
    v_cmp_eq_u32 vcc, 1, v12
    s_nop 5
    v_cndmask_b32 v14, v40, v41, vcc
    v_cmp_eq_u32 vcc, 2, v12
    s_nop 1
    v_cndmask_b32 v14, v14, v42, vcc
    v_cmp_eq_u32 vcc, 3, v12
    s_nop 1
    v_cndmask_b32 v14, v14, v43, vcc
    v_cmp_eq_u32 vcc, v13, v2
    s_nop 1
    s_and_saveexec_b64 s[10:11], vcc
    ds_write_b32 v11, v44
    ds_write_b32 v11, v14 offset:16
    s_mov_b64 exec, s[10:11]
    s_waitcnt lgkmcnt(0)
    s_barrier
    v_cmp_gt_u32 vcc, 16, v0
    s_nop 1
    s_and_saveexec_b64 s[10:11], vcc
    s_cbranch_execz K1_END
    ds_read_b128 v[40:43], v10
    ds_read_b128 v[44:47], v10 offset:16
    s_waitcnt lgkmcnt(0)
    v_add_f32 v40, v40, v41
    v_add_f32 v42, v42, v43
    v_add_f32 v44, v44, v45
    v_add_f32 v46, v46, v47
    v_add_f32 v40, v40, v42
    v_add_f32 v44, v44, v46
    v_mul_f32 v40, 0x3acccccd, v40
    v_mul_f32 v44, 0x3acccccd, v44
    v_fma_f32 v44, -v40, v40, v44
    v_max_f32 v44, 0, v44
    v_cvt_pk_bf16_f32 v12, v40, v40
    v_lshlrev_b32 v12, 16, v12
    v_cvt_pk_bf16_f32 v44, v44, v44
    v_lshlrev_b32 v44, 16, v44
    v_add_f32 v44, 0x3727c5ac, v44
    v_cvt_pk_bf16_f32 v44, v44, v44
    v_lshlrev_b32 v44, 16, v44
    v_sqrt_f32 v44, v44
    s_nop 0
    v_cvt_pk_bf16_f32 v44, v44, v44
    v_lshlrev_b32 v44, 16, v44
    v_lshrrev_b32 v12, 16, v12
    v_or_b32 v12, v12, v44
    global_store_dword v9, v12, s[12:13]
    s_endpgm
K1_EA:
    v_lshlrev_b32 v20, 3, v0
    v_sub_u32 v20, 2047, v20
    v_ffbh_u32 v21, v20
    v_sub_u32 v21, 24, v21
    v_max_i32 v21, 0, v21
    v_lshlrev_b32 v22, v21, 1
    v_lshrrev_b32 v22, 1, v22
    v_subrev_u32 v22, 1, v22
    v_max_i32 v22, 0, v22
    v_add_u32 v22, v20, v22
    v_min_u32 v23, 1, v21
    v_lshlrev_b32 v24, 8, v21
    v_add_u32 v24, 25360, v24
    v_mov_b32 v6, 26896
    v_subrev_u32 v25, 0, v20
    v_bfe_u32 v26, v25, v21, v23
    v_add3_u32 v26, v22, v26, 0
    v_lshrrev_b32 v26, v21, v26
    v_lshl_add_u32 v100, v26, 1, v24
    v_subrev_u32 v25, 1, v20
    v_bfe_u32 v26, v25, v21, v23
    v_add3_u32 v26, v22, v26, -1
    v_lshrrev_b32 v26, v21, v26
    v_lshl_add_u32 v101, v26, 1, v24
    v_subrev_u32 v25, 2, v20
    v_bfe_u32 v26, v25, v21, v23
    v_add3_u32 v26, v22, v26, -2
    v_lshrrev_b32 v26, v21, v26
    v_lshl_add_u32 v102, v26, 1, v24
    v_subrev_u32 v25, 3, v20
    v_bfe_u32 v26, v25, v21, v23
    v_add3_u32 v26, v22, v26, -3
    v_lshrrev_b32 v26, v21, v26
    v_lshl_add_u32 v103, v26, 1, v24
    v_subrev_u32 v25, 4, v20
    v_bfe_u32 v26, v25, v21, v23
    v_add3_u32 v26, v22, v26, -4
    v_lshrrev_b32 v26, v21, v26
    v_lshl_add_u32 v104, v26, 1, v24
    v_subrev_u32 v25, 5, v20
    v_bfe_u32 v26, v25, v21, v23
    v_add3_u32 v26, v22, v26, -5
    v_lshrrev_b32 v26, v21, v26
    v_lshl_add_u32 v105, v26, 1, v24
    v_subrev_u32 v25, 6, v20
    v_bfe_u32 v26, v25, v21, v23
    v_add3_u32 v26, v22, v26, -6
    v_lshrrev_b32 v26, v21, v26
    v_lshl_add_u32 v106, v26, 1, v24
    v_subrev_u32 v25, 7, v20
    v_bfe_u32 v26, v25, v21, v23
    v_add3_u32 v26, v22, v26, -7
    v_lshrrev_b32 v26, v21, v26
    v_lshl_add_u32 v107, v26, 1, v24
    v_subrev_u32 v25, 8, v20
    v_bfe_u32 v26, v25, v21, v23
    v_add3_u32 v26, v22, v26, -8
    v_lshrrev_b32 v26, v21, v26
    v_lshl_add_u32 v108, v26, 1, v24
    v_subrev_u32 v25, 9, v20
    v_bfe_u32 v26, v25, v21, v23
    v_add3_u32 v26, v22, v26, -9
    v_lshrrev_b32 v26, v21, v26
    v_lshl_add_u32 v109, v26, 1, v24
    v_subrev_u32 v25, 10, v20
    v_bfe_u32 v26, v25, v21, v23
    v_add3_u32 v26, v22, v26, -10
    v_lshrrev_b32 v26, v21, v26
    v_lshl_add_u32 v110, v26, 1, v24
    v_cmp_eq_u32 vcc, 223, v0
    v_mov_b32 v25, 25870
    s_nop 0
    v_cndmask_b32 v108, v108, v25, vcc
    v_mov_b32 v25, 25868
    v_cndmask_b32 v109, v109, v25, vcc
    v_mov_b32 v25, 25866
    v_cndmask_b32 v110, v110, v25, vcc
    v_cmp_eq_u32 vcc, 191, v0
    v_mov_b32 v25, 26128
    s_nop 0
    v_cndmask_b32 v108, v108, v25, vcc
    v_mov_b32 v25, 26126
    v_cndmask_b32 v109, v109, v25, vcc
    v_mov_b32 v25, 26124
    v_cndmask_b32 v110, v110, v25, vcc
    v_cmp_eq_u32 vcc, 127, v0
    v_mov_b32 v25, 26384
    s_nop 0
    v_cndmask_b32 v108, v108, v25, vcc
    v_mov_b32 v25, 26384
    v_cndmask_b32 v109, v109, v25, vcc
    v_mov_b32 v25, 26382
    v_cndmask_b32 v110, v110, v25, vcc
    v_cmp_eq_u32 vcc, 255, v0
    v_mov_b32 v25, 25358
    s_nop 0
    v_cndmask_b32 v108, v108, v25, vcc
    v_mov_b32 v25, 25356
    v_cndmask_b32 v109, v109, v25, vcc
    v_mov_b32 v25, 25354
    v_cndmask_b32 v110, v110, v25, vcc
    v_mov_b32 v2, 0
    v_lshlrev_b32 v3, 8, v100
    v_sub_u32 v25, v100, v101
    v_lshrrev_b32 v25, 1, v25
    v_lshl_or_b32 v2, v25, 0, v2
    v_sub_u32 v25, v100, v102
    v_lshrrev_b32 v25, 1, v25
    v_lshl_or_b32 v2, v25, 4, v2
    v_sub_u32 v25, v100, v103
    v_lshrrev_b32 v25, 1, v25
    v_lshl_or_b32 v2, v25, 8, v2
    v_sub_u32 v25, v100, v104
    v_lshrrev_b32 v25, 1, v25
    v_lshl_or_b32 v2, v25, 12, v2
    v_sub_u32 v25, v100, v105
    v_lshrrev_b32 v25, 1, v25
    v_lshl_or_b32 v2, v25, 16, v2
    v_sub_u32 v25, v100, v106
    v_lshrrev_b32 v25, 1, v25
    v_lshl_or_b32 v2, v25, 20, v2
    v_sub_u32 v25, v100, v107
    v_lshrrev_b32 v25, 1, v25
    v_lshl_or_b32 v2, v25, 24, v2
    v_sub_u32 v25, v100, v108
    v_lshrrev_b32 v25, 1, v25
    v_lshl_or_b32 v2, v25, 28, v2
    v_sub_u32 v25, v100, v109
    v_lshrrev_b32 v25, 1, v25
    v_lshl_or_b32 v3, v25, 0, v3
    v_sub_u32 v25, v100, v110
    v_lshrrev_b32 v25, 1, v25
    v_lshl_or_b32 v3, v25, 4, v3
    v_lshlrev_b32 v1, 3, v0
    v_add_u32 v1, 10911744, v1
    s_waitcnt lgkmcnt(0)
    global_store_dwordx2 v1, v[2:3], s[6:7]
    v_lshlrev_b32 v1, 4, v0
    v_add_u32 v1, 10944512, v1
    v_mov_b32 v4, 0
    v_mov_b32 v5, 0
    v_mov_b32 v6, 0
    v_mov_b32 v7, 0
    global_store_dwordx4 v1, v[4:7], s[6:7]
    v_add_u32 v1, 4096, v1
    global_store_dwordx4 v1, v[4:7], s[6:7]
    v_add_u32 v1, 4096, v1
    global_store_dwordx4 v1, v[4:7], s[6:7]
    v_add_u32 v1, 4096, v1
    global_store_dwordx4 v1, v[4:7], s[6:7]
    v_add_u32 v1, 4096, v1
    global_store_dwordx4 v1, v[4:7], s[6:7]
    v_add_u32 v1, 4096, v1
    global_store_dwordx4 v1, v[4:7], s[6:7]
    v_add_u32 v1, 4096, v1
    global_store_dwordx4 v1, v[4:7], s[6:7]
    v_add_u32 v1, 4096, v1
    global_store_dwordx4 v1, v[4:7], s[6:7]
    v_add_u32 v1, 4096, v1
    global_store_dwordx4 v1, v[4:7], s[6:7]
    v_add_u32 v1, 4096, v1
    global_store_dwordx4 v1, v[4:7], s[6:7]
    v_add_u32 v1, 4096, v1
    global_store_dwordx4 v1, v[4:7], s[6:7]
    v_add_u32 v1, 4096, v1
    global_store_dwordx4 v1, v[4:7], s[6:7]
K1_END:
    s_endpgm
.p2align 8
.globl k2_kernel
.type k2_kernel,@function
k2_kernel:
    s_cmp_ge_u32 s2, 768
    s_cbranch_scc1 K2_END
    s_load_dwordx2 s[6:7], s[0:1], 112
    s_load_dwordx2 s[4:5], s[0:1], 48
    s_setprio 3
    s_load_dwordx4 s[32:35], s[0:1], 72
    s_load_dwordx2 s[36:37], s[0:1], 88
    s_mov_b32 s29, s2
    s_and_b32 s8, s2, 7
    s_mul_i32 s8, s8, 80
    s_lshr_b32 s2, s2, 3
    s_mov_b32 s55, 0
    s_cmp_lt_u32 s2, 64
    s_cbranch_scc1 K2_MAPD
    s_and_b32 s55, s2, 1
    s_add_u32 s55, s55, 1
    s_sub_u32 s2, s2, 64
    s_lshr_b32 s2, s2, 1
    s_add_u32 s2, s2, 64
K2_MAPD:
    s_add_u32 s2, s2, s8
    v_lshrrev_b32 v3, 6, v0
    v_and_b32 v1, 63, v0
    v_lshlrev_b32 v2, 4, v0
    v_readfirstlane_b32 s3, v3
    v_lshlrev_b32 v4, 4, v1
    v_lshlrev_b32 v15, 5, v0
    v_lshlrev_b32 v5, 3, v0
    v_add_u32 v5, 10911744, v5
    s_mul_i32 s8, s2, 1536
    s_add_u32 s8, s8, 2621440
    s_lshl_b32 s10, s2, 12
    s_lshl_b32 s11, s2, 2
    s_add_u32 s11, s11, 10485760
    s_and_b32 s18, s2, 0xfffffffe
    s_lshl_b32 s18, s18, 1
    s_waitcnt lgkmcnt(0)
    s_add_u32 s12, s6, s8
    s_addc_u32 s13, s7, 0
    s_mov_b32 s14, 1536
    s_mov_b32 s15, 0x00020000
    s_add_u32 s16, s6, s10
    s_addc_u32 s17, s7, 0
    s_add_u32 s26, s6, 10878976
    s_addc_u32 s27, s7, 0
    buffer_load_dwordx4 v[16:19], v2, s[12:15], 0 offen
    global_load_dwordx2 v[24:25], v5, s[6:7]
    global_load_dwordx4 v[32:35], v2, s[16:17]
    global_load_dwordx4 v[40:43], v15, s[26:27]
    global_load_dwordx4 v[44:47], v15, s[26:27] offset:16
    s_add_u32 s20, s6, s11
    s_addc_u32 s21, s7, 0
    s_load_dword s22, s[20:21], 0
    s_load_dword s23, s[4:5], s18
    v_mov_b32 v36, 0
    v_mov_b32 v37, 0
    v_mov_b32 v38, 0
    v_mov_b32 v39, 0
    s_cmp_lg_u32 s3, 3
    s_cbranch_scc1 K2_NOZ
    v_bfe_u32 v7, v0, 2, 2
    v_mul_u32_u24 v7, 4160, v7
    v_and_b32 v8, 3, v0
    v_lshl_add_u32 v7, v8, 4, v7
    v_add_u32 v7, 12800, v7
    v_cmp_gt_u32 vcc, 32, v1
    s_nop 1
    v_cndmask_b32 v7, v7, v4, vcc
    ds_write_b128 v7, v[36:39]
K2_NOZ:
    v_and_b32 v9, 15, v0
    v_bfe_u32 v10, v0, 4, 2
    v_sub_u32 v11, 3, v9
    v_and_b32 v11, 3, v11
    v_mul_u32_u24 v12, 4158, v11
    v_lshlrev_b32 v13, 1, v9
    v_sub_u32 v12, v12, v13
    v_lshl_add_u32 v12, v10, 4, v12
    s_lshl_b32 s9, s3, 7
    s_sub_u32 s24, 8734, s9
    v_add_u32 v12, s24, v12
    v_lshlrev_b32 v13, 5, v9
    v_lshl_add_u32 v13, v10, 4, v13
    v_lshlrev_b32 v14, 5, v9
    v_lshl_add_u32 v14, v10, 3, v14
    s_sub_u32 s24, 416, s9
    v_add_u32 v13, s24, v13
    v_mov_b32 v15, 0xffff0000
    s_and_b32 s38, s29, 7
    s_lshr_b32 s39, s29, 3
    s_lshl_b32 s39, s39, 2
    s_add_u32 s39, s39, s3
    s_min_u32 s39, s39, 319
    s_mov_b32 s46, 2211840
    s_mov_b32 s47, 0x00020000
    s_cmp_ge_u32 s39, 160
    s_cbranch_scc1 K2_PFD
    s_cmp_ge_u32 s39, 80
    s_cselect_b32 s44, s34, s32
    s_cselect_b32 s45, s35, s33
    s_cselect_b32 s40, 80, 0
    s_sub_u32 s39, s39, s40
    s_mul_i32 s39, s39, 27648
    s_mul_i32 s40, s38, 7
    s_cmp_eq_u32 s38, 7
    s_cselect_b32 s41, 1, 0
    s_sub_u32 s40, s40, s41
    s_lshl_b32 s40, s40, 6
    s_and_b32 s40, s40, 0xffffff80
    s_add_u32 s39, s39, s40
    v_bfe_u32 v20, v0, 2, 3
    v_and_b32 v21, 3, v0
    v_mul_u32_u24 v20, 3456, v20
    s_branch K2_PFC
K2_PFD:
    s_mov_b32 s44, s36
    s_mov_b32 s45, s37
    s_sub_u32 s39, s39, 160
    s_mul_i32 s39, s39, 14080
    s_mul_i32 s40, s38, 160
    s_and_b32 s40, s40, 0xffffff80
    s_add_u32 s39, s39, s40
    v_bfe_u32 v20, v0, 1, 4
    v_min_u32 v20, 10, v20
    v_and_b32 v21, 1, v0
    v_mul_u32_u24 v20, 1280, v20
K2_PFC:
    v_lshl_add_u32 v20, v21, 7, v20
    v_add_u32 v130, s39, v20
    v_cmp_gt_u32 vcc, 96, v0
    v_add_u32 v8, 16, v2
    s_nop 0
    v_cndmask_b32 v8, 0, v8, vcc
    s_cmp_ge_u32 s3, 2
    s_cbranch_scc1 K2_NOTB
    s_waitcnt vmcnt(4)
    ds_write_b128 v8, v[16:19] offset:25344
K2_NOTB:
    s_waitcnt vmcnt(3)
    v_lshrrev_b32 v100, 8, v25
    v_bfe_u32 v22, v24, 0, 4
    v_mad_i32_i24 v101, v22, -2, v100
    v_bfe_u32 v22, v24, 4, 4
    v_mad_i32_i24 v102, v22, -2, v100
    v_bfe_u32 v22, v24, 8, 4
    v_mad_i32_i24 v103, v22, -2, v100
    v_bfe_u32 v22, v24, 12, 4
    v_mad_i32_i24 v104, v22, -2, v100
    v_bfe_u32 v22, v24, 16, 4
    v_mad_i32_i24 v105, v22, -2, v100
    v_bfe_u32 v22, v24, 20, 4
    v_mad_i32_i24 v106, v22, -2, v100
    v_bfe_u32 v22, v24, 24, 4
    v_mad_i32_i24 v107, v22, -2, v100
    v_bfe_u32 v22, v24, 28, 4
    v_mad_i32_i24 v108, v22, -2, v100
    v_bfe_u32 v22, v25, 0, 4
    v_mad_i32_i24 v109, v22, -2, v100
    v_bfe_u32 v22, v25, 4, 4
    v_mad_i32_i24 v110, v22, -2, v100
    s_waitcnt lgkmcnt(0)
    s_barrier
    ds_read_u16 v84, v100
    ds_read_u16 v85, v101
    ds_read_u16 v86, v102
    ds_read_u16 v87, v103
    ds_read_u16 v88, v104
    ds_read_u16 v89, v105
    ds_read_u16 v90, v106
    ds_read_u16 v91, v107
    ds_read_u16 v92, v108
    ds_read_u16 v93, v109
    ds_read_u16 v94, v110
    s_waitcnt lgkmcnt(0)
    v_lshl_or_b32 v112, v85, 16, v84
    v_lshl_or_b32 v113, v87, 16, v86
    v_lshl_or_b32 v114, v89, 16, v88
    v_lshl_or_b32 v115, v91, 16, v90
    v_lshl_or_b32 v116, v86, 16, v85
    v_lshl_or_b32 v117, v88, 16, v87
    v_lshl_or_b32 v118, v90, 16, v89
    v_lshl_or_b32 v119, v92, 16, v91
    v_lshl_or_b32 v120, v87, 16, v86
    v_lshl_or_b32 v121, v89, 16, v88
    v_lshl_or_b32 v122, v91, 16, v90
    v_lshl_or_b32 v123, v93, 16, v92
    v_lshl_or_b32 v124, v88, 16, v87
    v_lshl_or_b32 v125, v90, 16, v89
    v_lshl_or_b32 v126, v92, 16, v91
    v_lshl_or_b32 v127, v94, 16, v93
    ds_write_b128 v2, v[112:115] offset:8704
    ds_write_b128 v2, v[116:119] offset:12864
    ds_write_b128 v2, v[120:123] offset:17024
    ds_write_b128 v2, v[124:127] offset:21184
    s_waitcnt vmcnt(0)
    v_lshlrev_b32 v48, 16, v32
    v_and_b32 v49, v15, v32
    v_lshlrev_b32 v50, 16, v40
    v_lshlrev_b32 v51, 16, v41
    v_and_b32 v52, v15, v40
    v_and_b32 v53, v15, v41
    v_rcp_f32 v52, v52
    v_rcp_f32 v53, v53
    v_sub_f32 v48, v48, v50
    v_sub_f32 v49, v49, v51
    v_cvt_pk_bf16_f32 v50, v48, v49
    v_lshlrev_b32 v48, 16, v50
    v_and_b32 v49, v15, v50
    v_mul_f32 v48, v48, v52
    v_mul_f32 v49, v49, v53
    v_cvt_pk_bf16_f32 v50, v48, v49
    v_lshlrev_b32 v48, 16, v50
    v_and_b32 v49, v15, v50
    v_cvt_pk_f16_f32 v36, v48, v49
    v_lshlrev_b32 v56, 16, v33
    v_and_b32 v57, v15, v33
    v_lshlrev_b32 v58, 16, v42
    v_lshlrev_b32 v59, 16, v43
    v_and_b32 v60, v15, v42
    v_and_b32 v61, v15, v43
    v_rcp_f32 v60, v60
    v_rcp_f32 v61, v61
    v_sub_f32 v56, v56, v58
    v_sub_f32 v57, v57, v59
    v_cvt_pk_bf16_f32 v58, v56, v57
    v_lshlrev_b32 v56, 16, v58
    v_and_b32 v57, v15, v58
    v_mul_f32 v56, v56, v60
    v_mul_f32 v57, v57, v61
    v_cvt_pk_bf16_f32 v58, v56, v57
    v_lshlrev_b32 v56, 16, v58
    v_and_b32 v57, v15, v58
    v_cvt_pk_f16_f32 v37, v56, v57
    v_lshlrev_b32 v64, 16, v34
    v_and_b32 v65, v15, v34
    v_lshlrev_b32 v66, 16, v44
    v_lshlrev_b32 v67, 16, v45
    v_and_b32 v68, v15, v44
    v_and_b32 v69, v15, v45
    v_rcp_f32 v68, v68
    v_rcp_f32 v69, v69
    v_sub_f32 v64, v64, v66
    v_sub_f32 v65, v65, v67
    v_cvt_pk_bf16_f32 v66, v64, v65
    v_lshlrev_b32 v64, 16, v66
    v_and_b32 v65, v15, v66
    v_mul_f32 v64, v64, v68
    v_mul_f32 v65, v65, v69
    v_cvt_pk_bf16_f32 v66, v64, v65
    v_lshlrev_b32 v64, 16, v66
    v_and_b32 v65, v15, v66
    v_cvt_pk_f16_f32 v38, v64, v65
    v_lshlrev_b32 v72, 16, v35
    v_and_b32 v73, v15, v35
    v_lshlrev_b32 v74, 16, v46
    v_lshlrev_b32 v75, 16, v47
    v_and_b32 v76, v15, v46
    v_and_b32 v77, v15, v47
    v_rcp_f32 v76, v76
    v_rcp_f32 v77, v77
    v_sub_f32 v72, v72, v74
    v_sub_f32 v73, v73, v75
    v_cvt_pk_bf16_f32 v74, v72, v73
    v_lshlrev_b32 v72, 16, v74
    v_and_b32 v73, v15, v74
    v_mul_f32 v72, v72, v76
    v_mul_f32 v73, v73, v77
    v_cvt_pk_bf16_f32 v74, v72, v73
    v_lshlrev_b32 v72, 16, v74
    v_and_b32 v73, v15, v74
    v_cvt_pk_f16_f32 v39, v72, v73
    ds_write_b128 v2, v[36:39] offset:512
    s_mov_b32 s50, 0x76543210
    s_cmp_eq_u32 s55, 1
    s_cselect_b32 s50, 0xfef2f6f7, s50
    s_cmp_eq_u32 s55, 2
    s_cselect_b32 s50, 0x10f3f4f5, s50
    s_lshl_b32 s9, s3, 3
    s_lshr_b32 s50, s50, s9
    s_bfe_u32 s51, s50, 0x40004
    s_and_b32 s50, s50, 15
    s_and_b32 s9, s50, 7
    s_lshl_b32 s9, s9, 9
    v_add_u32 v6, s9, v14
    s_and_b32 s9, s51, 7
    s_lshl_b32 s9, s9, 9
    v_add_u32 v7, s9, v14
    global_load_dwordx2 v[0:1], v6, s[16:17]
    global_load_dwordx2 v[2:3], v7, s[16:17]
    buffer_load_dword v5, v130, s[44:47], 0 offen
    s_waitcnt lgkmcnt(0)
    s_barrier
    s_setprio 0
    s_cmp_eq_u32 s55, 1
    s_cbranch_scc1 K2_VA
    s_cmp_eq_u32 s55, 2
    s_cbranch_scc1 K2_VB
    ds_read_b64 v[48:49], v12 offset:4032
    ds_read_b64 v[50:51], v12 offset:4040
    ds_read_b128 v[80:83], v13 offset:64
    ds_read_b64 v[52:53], v12 offset:3520
    ds_read_b64 v[54:55], v12 offset:3528
    ds_read_b128 v[84:87], v13 offset:576
    ds_read_b64 v[56:57], v12 offset:3008
    ds_read_b64 v[58:59], v12 offset:3016
    ds_read_b128 v[88:91], v13 offset:1088
    s_waitcnt lgkmcnt(6)
    v_mfma_f32_16x16x32_f16 v[16:19], v[48:51], v[80:83], 0
    ds_read_b64 v[60:61], v12 offset:2496
    s_waitcnt lgkmcnt(4)
    v_mfma_f32_16x16x32_f16 v[20:23], v[52:55], v[80:83], 0
    ds_read_b64 v[62:63], v12 offset:2504
    v_mfma_f32_16x16x32_f16 v[24:27], v[52:55], v[84:87], 0
    ds_read_b128 v[92:95], v13 offset:1600
    v_mfma_f32_16x16x32_f16 v[20:23], v[48:51], v[84:87], v[20:23]
    ds_read_b64 v[64:65], v12 offset:1984
    s_waitcnt lgkmcnt(4)
    v_mfma_f32_16x16x32_f16 v[24:27], v[56:59], v[80:83], v[24:27]
    ds_read_b64 v[66:67], v12 offset:1992
    v_mfma_f32_16x16x32_f16 v[28:31], v[56:59], v[84:87], 0
    ds_read_b128 v[96:99], v13 offset:2112
    v_mfma_f32_16x16x32_f16 v[32:35], v[56:59], v[88:91], 0
    ds_read_b64 v[68:69], v12 offset:1472
    v_mfma_f32_16x16x32_f16 v[24:27], v[48:51], v[88:91], v[24:27]
    ds_read_b64 v[70:71], v12 offset:1480
    v_mfma_f32_16x16x32_f16 v[28:31], v[52:55], v[88:91], v[28:31]
    ds_read_b128 v[100:103], v13 offset:2624
    s_waitcnt lgkmcnt(6)
    v_mfma_f32_16x16x32_f16 v[28:31], v[60:63], v[80:83], v[28:31]
    ds_read_b64 v[72:73], v12 offset:960
    v_mfma_f32_16x16x32_f16 v[32:35], v[60:63], v[84:87], v[32:35]
    ds_read_b64 v[74:75], v12 offset:968
    v_mfma_f32_16x16x32_f16 v[36:39], v[60:63], v[88:91], 0
    ds_read_b128 v[104:107], v13 offset:3136
    v_mfma_f32_16x16x32_f16 v[40:43], v[60:63], v[92:95], 0
    ds_read_b64 v[76:77], v12 offset:448
    v_mfma_f32_16x16x32_f16 v[28:31], v[48:51], v[92:95], v[28:31]
    ds_read_b64 v[78:79], v12 offset:456
    v_mfma_f32_16x16x32_f16 v[32:35], v[52:55], v[92:95], v[32:35]
    ds_read_b128 v[108:111], v13 offset:3648
    v_mfma_f32_16x16x32_f16 v[36:39], v[56:59], v[92:95], v[36:39]
    ds_read_b64 v[112:113], v12 offset:3968
    s_waitcnt lgkmcnt(10)
    v_mfma_f32_16x16x32_f16 v[32:35], v[64:67], v[80:83], v[32:35]
    ds_read_b64 v[114:115], v12 offset:3976
    v_mfma_f32_16x16x32_f16 v[36:39], v[64:67], v[84:87], v[36:39]
    ds_read_b128 v[140:143], v13 offset:0
    v_mfma_f32_16x16x32_f16 v[40:43], v[64:67], v[88:91], v[40:43]
    ds_read_b64 v[116:117], v12 offset:3456
    v_mfma_f32_16x16x32_f16 v[44:47], v[64:67], v[92:95], 0
    ds_read_b64 v[118:119], v12 offset:3464
    v_mfma_f32_16x16x32_f16 v[32:35], v[48:51], v[96:99], v[32:35]
    ds_read_b128 v[144:147], v13 offset:512
    v_mfma_f32_16x16x32_f16 v[36:39], v[52:55], v[96:99], v[36:39]
    ds_read_b64 v[120:121], v12 offset:2944
    v_mfma_f32_16x16x32_f16 v[40:43], v[56:59], v[96:99], v[40:43]
    ds_read_b64 v[122:123], v12 offset:2952
    v_mfma_f32_16x16x32_f16 v[44:47], v[60:63], v[96:99], v[44:47]
    ds_read_b128 v[148:151], v13 offset:1024
    s_waitcnt lgkmcnt(15)
    v_mfma_f32_16x16x32_f16 v[36:39], v[68:71], v[80:83], v[36:39]
    ds_read_b64 v[124:125], v12 offset:2432
    v_mfma_f32_16x16x32_f16 v[40:43], v[68:71], v[84:87], v[40:43]
    ds_read_b64 v[126:127], v12 offset:2440
    v_mfma_f32_16x16x32_f16 v[44:47], v[68:71], v[88:91], v[44:47]
    ds_read_b128 v[152:155], v13 offset:1536
    v_mfma_f32_16x16x32_f16 v[36:39], v[48:51], v[100:103], v[36:39]
    ds_read_b64 v[128:129], v12 offset:1920
    v_mfma_f32_16x16x32_f16 v[40:43], v[52:55], v[100:103], v[40:43]
    ds_read_b64 v[130:131], v12 offset:1928
    v_mfma_f32_16x16x32_f16 v[44:47], v[56:59], v[100:103], v[44:47]
    ds_read_b128 v[156:159], v13 offset:2048
    s_waitcnt lgkmcnt(15)
    v_mfma_f32_16x16x32_f16 v[40:43], v[72:75], v[80:83], v[40:43]
    ds_read_b64 v[132:133], v12 offset:1408
    v_mfma_f32_16x16x32_f16 v[44:47], v[72:75], v[84:87], v[44:47]
    ds_read_b64 v[134:135], v12 offset:1416
    v_mfma_f32_16x16x32_f16 v[40:43], v[48:51], v[104:107], v[40:43]
    ds_read_b128 v[160:163], v13 offset:2560
    v_mfma_f32_16x16x32_f16 v[44:47], v[52:55], v[104:107], v[44:47]
    ds_read_b64 v[136:137], v12 offset:896
    s_waitcnt lgkmcnt(15)
    v_mfma_f32_16x16x32_f16 v[44:47], v[76:79], v[80:83], v[44:47]
    ds_read_b64 v[138:139], v12 offset:904
    v_mfma_f32_16x16x32_f16 v[44:47], v[48:51], v[108:111], v[44:47]
    ds_read_b128 v[164:167], v13 offset:3072
    s_waitcnt lgkmcnt(15)
    v_mfma_f32_16x16x32_f16 v[16:19], v[112:115], v[140:143], v[16:19]
    ds_read_b64 v[76:77], v12 offset:384
    s_waitcnt lgkmcnt(15)
    v_mfma_f32_16x16x32_f16 v[20:23], v[116:119], v[140:143], v[20:23]
    ds_read_b64 v[78:79], v12 offset:392
    v_mfma_f32_16x16x32_f16 v[24:27], v[116:119], v[144:147], v[24:27]
    ds_read_b128 v[108:111], v13 offset:3584
    v_mfma_f32_16x16x32_f16 v[20:23], v[112:115], v[144:147], v[20:23]
    s_waitcnt lgkmcnt(15)
    v_mfma_f32_16x16x32_f16 v[24:27], v[120:123], v[140:143], v[24:27]
    v_mfma_f32_16x16x32_f16 v[28:31], v[120:123], v[144:147], v[28:31]
    v_mfma_f32_16x16x32_f16 v[32:35], v[120:123], v[148:151], v[32:35]
    v_mfma_f32_16x16x32_f16 v[24:27], v[112:115], v[148:151], v[24:27]
    v_mfma_f32_16x16x32_f16 v[28:31], v[116:119], v[148:151], v[28:31]
    s_waitcnt lgkmcnt(12)
    v_mfma_f32_16x16x32_f16 v[28:31], v[124:127], v[140:143], v[28:31]
    v_mfma_f32_16x16x32_f16 v[32:35], v[124:127], v[144:147], v[32:35]
    v_mfma_f32_16x16x32_f16 v[36:39], v[124:127], v[148:151], v[36:39]
    v_mfma_f32_16x16x32_f16 v[40:43], v[124:127], v[152:155], v[40:43]
    v_mfma_f32_16x16x32_f16 v[28:31], v[112:115], v[152:155], v[28:31]
    v_mfma_f32_16x16x32_f16 v[32:35], v[116:119], v[152:155], v[32:35]
    v_mfma_f32_16x16x32_f16 v[36:39], v[120:123], v[152:155], v[36:39]
    s_waitcnt lgkmcnt(9)
    v_mfma_f32_16x16x32_f16 v[32:35], v[128:131], v[140:143], v[32:35]
    v_mfma_f32_16x16x32_f16 v[36:39], v[128:131], v[144:147], v[36:39]
    v_mfma_f32_16x16x32_f16 v[40:43], v[128:131], v[148:151], v[40:43]
    v_mfma_f32_16x16x32_f16 v[44:47], v[128:131], v[152:155], v[44:47]
    v_mfma_f32_16x16x32_f16 v[32:35], v[112:115], v[156:159], v[32:35]
    v_mfma_f32_16x16x32_f16 v[36:39], v[116:119], v[156:159], v[36:39]
    v_mfma_f32_16x16x32_f16 v[40:43], v[120:123], v[156:159], v[40:43]
    v_mfma_f32_16x16x32_f16 v[44:47], v[124:127], v[156:159], v[44:47]
    s_waitcnt lgkmcnt(6)
    v_mfma_f32_16x16x32_f16 v[36:39], v[132:135], v[140:143], v[36:39]
    v_mfma_f32_16x16x32_f16 v[40:43], v[132:135], v[144:147], v[40:43]
    v_mfma_f32_16x16x32_f16 v[44:47], v[132:135], v[148:151], v[44:47]
    v_mfma_f32_16x16x32_f16 v[36:39], v[112:115], v[160:163], v[36:39]
    v_mfma_f32_16x16x32_f16 v[40:43], v[116:119], v[160:163], v[40:43]
    v_mfma_f32_16x16x32_f16 v[44:47], v[120:123], v[160:163], v[44:47]
    s_waitcnt lgkmcnt(3)
    v_mfma_f32_16x16x32_f16 v[40:43], v[136:139], v[140:143], v[40:43]
    v_mfma_f32_16x16x32_f16 v[44:47], v[136:139], v[144:147], v[44:47]
    v_mfma_f32_16x16x32_f16 v[40:43], v[112:115], v[164:167], v[40:43]
    v_mfma_f32_16x16x32_f16 v[44:47], v[116:119], v[164:167], v[44:47]
    s_waitcnt lgkmcnt(0)
    v_mfma_f32_16x16x32_f16 v[44:47], v[76:79], v[140:143], v[44:47]
    v_mfma_f32_16x16x32_f16 v[44:47], v[112:115], v[108:111], v[44:47]
    s_setprio 0
    s_lshl_b32 s9, s3, 10
    s_add_u32 s9, s9, 8704
    v_add_u32 v6, s9, v4
    s_lshl_b32 s52, s50, 9
    s_and_b32 s53, s51, 7
    s_lshl_b32 s53, s53, 9
    v_add_u32 v7, s52, v14
    v_add_u32 v11, s53, v14
    ds_read_b64 v[48:49], v7 offset:512
    ds_read_b64 v[50:51], v11 offset:512
    s_barrier
    s_cmp_eq_u32 s50, 0
    s_cbranch_scc1 K2_OWNF0_0
    s_cmp_eq_u32 s51, 0
    s_cbranch_scc1 K2_OWNF0_1
    ds_write_b128 v6, v[16:19] offset:0
K2_OWNBF0:
    s_cmp_eq_u32 s50, 1
    s_cbranch_scc1 K2_OWNF1_0
    s_cmp_eq_u32 s51, 1
    s_cbranch_scc1 K2_OWNF1_1
    ds_write_b128 v6, v[20:23] offset:4096
K2_OWNBF1:
    s_cmp_eq_u32 s50, 2
    s_cbranch_scc1 K2_OWNF2_0
    s_cmp_eq_u32 s51, 2
    s_cbranch_scc1 K2_OWNF2_1
    ds_write_b128 v6, v[24:27] offset:8192
K2_OWNBF2:
    s_cmp_eq_u32 s50, 3
    s_cbranch_scc1 K2_OWNF3_0
    s_cmp_eq_u32 s51, 3
    s_cbranch_scc1 K2_OWNF3_1
    ds_write_b128 v6, v[28:31] offset:12288
K2_OWNBF3:
    s_cmp_eq_u32 s50, 4
    s_cbranch_scc1 K2_OWNF4_0
    s_cmp_eq_u32 s51, 4
    s_cbranch_scc1 K2_OWNF4_1
    ds_write_b128 v6, v[32:35] offset:16384
K2_OWNBF4:
    s_cmp_eq_u32 s50, 5
    s_cbranch_scc1 K2_OWNF5_0
    s_cmp_eq_u32 s51, 5
    s_cbranch_scc1 K2_OWNF5_1
    ds_write_b128 v6, v[36:39] offset:20480
K2_OWNBF5:
    s_cmp_eq_u32 s50, 6
    s_cbranch_scc1 K2_OWNF6_0
    s_cmp_eq_u32 s51, 6
    s_cbranch_scc1 K2_OWNF6_1
    ds_write_b128 v6, v[40:43] offset:24576
K2_OWNBF6:
    s_cmp_eq_u32 s50, 7
    s_cbranch_scc1 K2_OWNF7_0
    s_cmp_eq_u32 s51, 7
    s_cbranch_scc1 K2_OWNF7_1
    ds_write_b128 v6, v[44:47] offset:28672
K2_OWNBF7:
    v_mul_u32_u24 v8, 20480, v9
    v_lshl_add_u32 v8, v10, 3, v8
    s_lshl_b32 s9, s2, 5
    v_add_u32 v8, s9, v8
    s_mul_i32 s9, s50, 327680
    s_and_b32 s54, s51, 7
    s_mul_i32 s54, s54, 327680
    v_add_u32 v118, s54, v8
    v_add_u32 v8, s9, v8
    s_lshl_b32 s52, s52, 3
    s_lshl_b32 s53, s53, 3
    s_add_u32 s52, s52, 8704
    s_add_u32 s53, s53, 8704
    s_add_u32 s9, s3, 1
    s_and_b32 s9, s9, 3
    s_lshl_b32 s9, s9, 10
    s_add_u32 s54, s9, s52
    v_add_u32 v112, s54, v4
    s_add_u32 s54, s9, s53
    v_add_u32 v115, s54, v4
    s_add_u32 s9, s3, 2
    s_and_b32 s9, s9, 3
    s_lshl_b32 s9, s9, 10
    s_add_u32 s54, s9, s52
    v_add_u32 v113, s54, v4
    s_add_u32 s54, s9, s53
    v_add_u32 v116, s54, v4
    s_add_u32 s9, s3, 3
    s_and_b32 s9, s9, 3
    s_lshl_b32 s9, s9, 10
    s_add_u32 s54, s9, s52
    v_add_u32 v114, s54, v4
    s_add_u32 s54, s9, s53
    v_add_u32 v117, s54, v4
    s_bitcmp1_b32 s2, 0
    s_cselect_b32 s24, 0, 16
    s_lshl_b32 s23, s23, s24
    s_and_b32 s23, s23, 0xffff0000
    s_add_u32 s16, s6, 7864320
    s_addc_u32 s17, s7, 0
    s_waitcnt vmcnt(1) lgkmcnt(0)
    v_cvt_f32_f16 v96, v48
    v_cvt_f32_f16_sdwa v97, v48 dst_sel:DWORD dst_unused:UNUSED_PAD src0_sel:WORD_1
    v_cvt_f32_f16 v98, v49
    v_cvt_f32_f16_sdwa v99, v49 dst_sel:DWORD dst_unused:UNUSED_PAD src0_sel:WORD_1
    v_mul_f32 v96, s23, v96
    v_mul_f32 v97, s23, v97
    v_mul_f32 v98, s23, v98
    v_mul_f32 v99, s23, v99
    v_cvt_pk_bf16_f32 v48, v96, v97
    v_cvt_pk_bf16_f32 v49, v98, v99
    v_lshlrev_b32 v96, 16, v48
    v_and_b32 v97, v15, v48
    v_lshlrev_b32 v98, 16, v49
    v_and_b32 v99, v15, v49
    v_lshlrev_b32 v104, 16, v0
    v_and_b32 v105, v15, v0
    v_lshlrev_b32 v106, 16, v1
    v_and_b32 v107, v15, v1
    v_cvt_f32_f16 v100, v50
    v_cvt_f32_f16_sdwa v101, v50 dst_sel:DWORD dst_unused:UNUSED_PAD src0_sel:WORD_1
    v_cvt_f32_f16 v102, v51
    v_cvt_f32_f16_sdwa v103, v51 dst_sel:DWORD dst_unused:UNUSED_PAD src0_sel:WORD_1
    v_mul_f32 v100, s23, v100
    v_mul_f32 v101, s23, v101
    v_mul_f32 v102, s23, v102
    v_mul_f32 v103, s23, v103
    v_cvt_pk_bf16_f32 v50, v100, v101
    v_cvt_pk_bf16_f32 v51, v102, v103
    v_lshlrev_b32 v100, 16, v50
    v_and_b32 v101, v15, v50
    v_lshlrev_b32 v102, 16, v51
    v_and_b32 v103, v15, v51
    v_lshlrev_b32 v108, 16, v2
    v_and_b32 v109, v15, v2
    v_lshlrev_b32 v110, 16, v3
    v_and_b32 v111, v15, v3
    s_barrier
    ds_read_b128 v[60:63], v112
    ds_read_b128 v[64:67], v113
    ds_read_b128 v[68:71], v114
    ds_read_b128 v[76:79], v115
    ds_read_b128 v[80:83], v116
    ds_read_b128 v[84:87], v117
    s_waitcnt lgkmcnt(3)
    v_pk_add_f32 v[56:57], v[56:57], v[60:61]
    v_pk_add_f32 v[58:59], v[58:59], v[62:63]
    v_pk_add_f32 v[64:65], v[64:65], v[68:69]
    v_pk_add_f32 v[66:67], v[66:67], v[70:71]
    v_pk_add_f32 v[56:57], v[56:57], v[64:65]
    v_pk_add_f32 v[58:59], v[58:59], v[66:67]
    v_mul_f32 v56, s22, v56
    v_mul_f32 v57, s22, v57
    v_mul_f32 v58, s22, v58
    v_mul_f32 v59, s22, v59
    v_cvt_pk_bf16_f32 v60, v56, v57
    v_cvt_pk_bf16_f32 v61, v58, v59
    v_lshlrev_b32 v56, 16, v60
    v_and_b32 v57, v15, v60
    v_lshlrev_b32 v58, 16, v61
    v_and_b32 v59, v15, v61
    v_pk_add_f32 v[56:57], v[56:57], v[96:97]
    v_pk_add_f32 v[58:59], v[58:59], v[98:99]
    v_cvt_pk_bf16_f32 v60, v56, v57
    v_cvt_pk_bf16_f32 v61, v58, v59
    v_lshlrev_b32 v56, 16, v60
    v_and_b32 v57, v15, v60
    v_lshlrev_b32 v58, 16, v61
    v_and_b32 v59, v15, v61
    v_pk_add_f32 v[56:57], v[56:57], v[104:105]
    v_pk_add_f32 v[58:59], v[58:59], v[106:107]
    v_cvt_pk_bf16_f32 v60, v56, v57
    v_cvt_pk_bf16_f32 v61, v58, v59
    global_store_dwordx2 v8, v[60:61], s[16:17]
    s_waitcnt lgkmcnt(0)
    v_pk_add_f32 v[72:73], v[72:73], v[76:77]
    v_pk_add_f32 v[74:75], v[74:75], v[78:79]
    v_pk_add_f32 v[80:81], v[80:81], v[84:85]
    v_pk_add_f32 v[82:83], v[82:83], v[86:87]
    v_pk_add_f32 v[72:73], v[72:73], v[80:81]
    v_pk_add_f32 v[74:75], v[74:75], v[82:83]
    v_mul_f32 v72, s22, v72
    v_mul_f32 v73, s22, v73
    v_mul_f32 v74, s22, v74
    v_mul_f32 v75, s22, v75
    v_cvt_pk_bf16_f32 v76, v72, v73
    v_cvt_pk_bf16_f32 v77, v74, v75
    v_lshlrev_b32 v72, 16, v76
    v_and_b32 v73, v15, v76
    v_lshlrev_b32 v74, 16, v77
    v_and_b32 v75, v15, v77
    v_pk_add_f32 v[72:73], v[72:73], v[100:101]
    v_pk_add_f32 v[74:75], v[74:75], v[102:103]
    v_cvt_pk_bf16_f32 v76, v72, v73
    v_cvt_pk_bf16_f32 v77, v74, v75
    v_lshlrev_b32 v72, 16, v76
    v_and_b32 v73, v15, v76
    v_lshlrev_b32 v74, 16, v77
    v_and_b32 v75, v15, v77
    v_pk_add_f32 v[72:73], v[72:73], v[108:109]
    v_pk_add_f32 v[74:75], v[74:75], v[110:111]
    v_cvt_pk_bf16_f32 v76, v72, v73
    v_cvt_pk_bf16_f32 v77, v74, v75
    global_store_dwordx2 v118, v[76:77], s[16:17]
K2_FINF:
    s_mov_b32 s2, s29
    s_endpgm
K2_OWNF0_0:
    s_nop 7
    v_mov_b64 v[56:57], v[16:17]
    v_mov_b64 v[58:59], v[18:19]
    s_branch K2_OWNBF0
K2_OWNF0_1:
    s_nop 7
    v_mov_b64 v[72:73], v[16:17]
    v_mov_b64 v[74:75], v[18:19]
    s_branch K2_OWNBF0
K2_OWNF1_0:
    s_nop 7
    v_mov_b64 v[56:57], v[20:21]
    v_mov_b64 v[58:59], v[22:23]
    s_branch K2_OWNBF1
K2_OWNF1_1:
    s_nop 7
    v_mov_b64 v[72:73], v[20:21]
    v_mov_b64 v[74:75], v[22:23]
    s_branch K2_OWNBF1
K2_OWNF2_0:
    s_nop 7
    v_mov_b64 v[56:57], v[24:25]
    v_mov_b64 v[58:59], v[26:27]
    s_branch K2_OWNBF2
K2_OWNF2_1:
    s_nop 7
    v_mov_b64 v[72:73], v[24:25]
    v_mov_b64 v[74:75], v[26:27]
    s_branch K2_OWNBF2
K2_OWNF3_0:
    s_nop 7
    v_mov_b64 v[56:57], v[28:29]
    v_mov_b64 v[58:59], v[30:31]
    s_branch K2_OWNBF3
K2_OWNF3_1:
    s_nop 7
    v_mov_b64 v[72:73], v[28:29]
    v_mov_b64 v[74:75], v[30:31]
    s_branch K2_OWNBF3
K2_OWNF4_0:
    s_nop 7
    v_mov_b64 v[56:57], v[32:33]
    v_mov_b64 v[58:59], v[34:35]
    s_branch K2_OWNBF4
K2_OWNF4_1:
    s_nop 7
    v_mov_b64 v[72:73], v[32:33]
    v_mov_b64 v[74:75], v[34:35]
    s_branch K2_OWNBF4
K2_OWNF5_0:
    s_nop 7
    v_mov_b64 v[56:57], v[36:37]
    v_mov_b64 v[58:59], v[38:39]
    s_branch K2_OWNBF5
K2_OWNF5_1:
    s_nop 7
    v_mov_b64 v[72:73], v[36:37]
    v_mov_b64 v[74:75], v[38:39]
    s_branch K2_OWNBF5
K2_OWNF6_0:
    s_nop 7
    v_mov_b64 v[56:57], v[40:41]
    v_mov_b64 v[58:59], v[42:43]
    s_branch K2_OWNBF6
K2_OWNF6_1:
    s_nop 7
    v_mov_b64 v[72:73], v[40:41]
    v_mov_b64 v[74:75], v[42:43]
    s_branch K2_OWNBF6
K2_OWNF7_0:
    s_nop 7
    v_mov_b64 v[56:57], v[44:45]
    v_mov_b64 v[58:59], v[46:47]
    s_branch K2_OWNBF7
K2_OWNF7_1:
    s_nop 7
    v_mov_b64 v[72:73], v[44:45]
    v_mov_b64 v[74:75], v[46:47]
    s_branch K2_OWNBF7
K2_VA:
    ds_read_b64 v[48:49], v12 offset:4032
    ds_read_b64 v[50:51], v12 offset:4040
    ds_read_b128 v[80:83], v13 offset:64
    ds_read_b64 v[52:53], v12 offset:3520
    ds_read_b64 v[54:55], v12 offset:3528
    ds_read_b128 v[84:87], v13 offset:576
    ds_read_b64 v[56:57], v12 offset:3008
    ds_read_b64 v[58:59], v12 offset:3016
    ds_read_b128 v[88:91], v13 offset:1088
    ds_read_b64 v[60:61], v12 offset:2496
    ds_read_b64 v[62:63], v12 offset:2504
    ds_read_b128 v[92:95], v13 offset:1600
    ds_read_b64 v[64:65], v12 offset:1984
    ds_read_b64 v[66:67], v12 offset:1992
    ds_read_b128 v[96:99], v13 offset:2112
    s_waitcnt lgkmcnt(9)
    v_mfma_f32_16x16x32_f16 v[24:27], v[52:55], v[84:87], 0
    ds_read_b64 v[68:69], v12 offset:1472
    ds_read_b64 v[70:71], v12 offset:1480
    s_waitcnt lgkmcnt(8)
    v_mfma_f32_16x16x32_f16 v[24:27], v[56:59], v[80:83], v[24:27]
    ds_read_b128 v[100:103], v13 offset:2624
    ds_read_b64 v[72:73], v12 offset:960
    v_mfma_f32_16x16x32_f16 v[24:27], v[48:51], v[88:91], v[24:27]
    ds_read_b64 v[74:75], v12 offset:968
    ds_read_b128 v[104:107], v13 offset:3136
    s_waitcnt lgkmcnt(9)
    v_mfma_f32_16x16x32_f16 v[40:43], v[60:63], v[92:95], 0
    ds_read_b64 v[76:77], v12 offset:448
    ds_read_b64 v[78:79], v12 offset:456
    s_waitcnt lgkmcnt(8)
    v_mfma_f32_16x16x32_f16 v[40:43], v[64:67], v[88:91], v[40:43]
    ds_read_b128 v[108:111], v13 offset:3648
    ds_read_b64 v[112:113], v12 offset:3968
    v_mfma_f32_16x16x32_f16 v[44:47], v[64:67], v[92:95], 0
    ds_read_b64 v[114:115], v12 offset:3976
    ds_read_b128 v[140:143], v13 offset:0
    v_mfma_f32_16x16x32_f16 v[40:43], v[56:59], v[96:99], v[40:43]
    ds_read_b64 v[116:117], v12 offset:3456
    ds_read_b64 v[118:119], v12 offset:3464
    v_mfma_f32_16x16x32_f16 v[44:47], v[60:63], v[96:99], v[44:47]
    ds_read_b128 v[144:147], v13 offset:512
    ds_read_b64 v[120:121], v12 offset:2944
    s_waitcnt lgkmcnt(13)
    v_mfma_f32_16x16x32_f16 v[40:43], v[68:71], v[84:87], v[40:43]
    ds_read_b64 v[122:123], v12 offset:2952
    ds_read_b128 v[148:151], v13 offset:1024
    v_mfma_f32_16x16x32_f16 v[44:47], v[68:71], v[88:91], v[44:47]
    ds_read_b64 v[124:125], v12 offset:2432
    ds_read_b64 v[126:127], v12 offset:2440
    v_mfma_f32_16x16x32_f16 v[40:43], v[52:55], v[100:103], v[40:43]
    ds_read_b128 v[152:155], v13 offset:1536
    ds_read_b64 v[128:129], v12 offset:1920
    v_mfma_f32_16x16x32_f16 v[44:47], v[56:59], v[100:103], v[44:47]
    ds_read_b64 v[130:131], v12 offset:1928
    ds_read_b128 v[156:159], v13 offset:2048
    s_waitcnt lgkmcnt(15)
    v_mfma_f32_16x16x32_f16 v[40:43], v[72:75], v[80:83], v[40:43]
    ds_read_b64 v[132:133], v12 offset:1408
    ds_read_b64 v[134:135], v12 offset:1416
    v_mfma_f32_16x16x32_f16 v[44:47], v[72:75], v[84:87], v[44:47]
    ds_read_b128 v[160:163], v13 offset:2560
    ds_read_b64 v[136:137], v12 offset:896
    v_mfma_f32_16x16x32_f16 v[40:43], v[48:51], v[104:107], v[40:43]
    ds_read_b64 v[138:139], v12 offset:904
    ds_read_b128 v[164:167], v13 offset:3072
    v_mfma_f32_16x16x32_f16 v[44:47], v[52:55], v[104:107], v[44:47]
    s_waitcnt lgkmcnt(15)
    v_mfma_f32_16x16x32_f16 v[44:47], v[76:79], v[80:83], v[44:47]
    v_mfma_f32_16x16x32_f16 v[44:47], v[48:51], v[108:111], v[44:47]
    s_waitcnt lgkmcnt(15)
    v_mfma_f32_16x16x32_f16 v[24:27], v[116:119], v[144:147], v[24:27]
    ds_read_b64 v[76:77], v12 offset:384
    ds_read_b64 v[78:79], v12 offset:392
    s_waitcnt lgkmcnt(14)
    v_mfma_f32_16x16x32_f16 v[24:27], v[120:123], v[140:143], v[24:27]
    ds_read_b128 v[108:111], v13 offset:3584
    v_mfma_f32_16x16x32_f16 v[24:27], v[112:115], v[148:151], v[24:27]
    s_waitcnt lgkmcnt(12)
    v_mfma_f32_16x16x32_f16 v[40:43], v[124:127], v[152:155], v[40:43]
    s_waitcnt lgkmcnt(9)
    v_mfma_f32_16x16x32_f16 v[40:43], v[128:131], v[148:151], v[40:43]
    v_mfma_f32_16x16x32_f16 v[44:47], v[128:131], v[152:155], v[44:47]
    v_mfma_f32_16x16x32_f16 v[40:43], v[120:123], v[156:159], v[40:43]
    v_mfma_f32_16x16x32_f16 v[44:47], v[124:127], v[156:159], v[44:47]
    s_waitcnt lgkmcnt(6)
    v_mfma_f32_16x16x32_f16 v[40:43], v[132:135], v[144:147], v[40:43]
    v_mfma_f32_16x16x32_f16 v[44:47], v[132:135], v[148:151], v[44:47]
    v_mfma_f32_16x16x32_f16 v[40:43], v[116:119], v[160:163], v[40:43]
    v_mfma_f32_16x16x32_f16 v[44:47], v[120:123], v[160:163], v[44:47]
    s_waitcnt lgkmcnt(3)
    v_mfma_f32_16x16x32_f16 v[40:43], v[136:139], v[140:143], v[40:43]
    v_mfma_f32_16x16x32_f16 v[44:47], v[136:139], v[144:147], v[44:47]
    v_mfma_f32_16x16x32_f16 v[40:43], v[112:115], v[164:167], v[40:43]
    v_mfma_f32_16x16x32_f16 v[44:47], v[116:119], v[164:167], v[44:47]
    s_waitcnt lgkmcnt(0)
    v_mfma_f32_16x16x32_f16 v[44:47], v[76:79], v[140:143], v[44:47]
    v_mfma_f32_16x16x32_f16 v[44:47], v[112:115], v[108:111], v[44:47]
    s_setprio 0
    s_lshl_b32 s9, s3, 10
    s_add_u32 s9, s9, 8704
    v_add_u32 v6, s9, v4
    s_lshl_b32 s52, s50, 9
    s_and_b32 s53, s51, 7
    s_lshl_b32 s53, s53, 9
    v_add_u32 v7, s52, v14
    v_add_u32 v11, s53, v14
    ds_read_b64 v[48:49], v7 offset:512
    ds_read_b64 v[50:51], v11 offset:512
    s_barrier
    s_cmp_eq_u32 s50, 2
    s_cbranch_scc1 K2_OWNA2_0
    s_cmp_eq_u32 s51, 2
    s_cbranch_scc1 K2_OWNA2_1
    ds_write_b128 v6, v[24:27] offset:8192
K2_OWNBA2:
    s_cmp_eq_u32 s50, 6
    s_cbranch_scc1 K2_OWNA6_0
    s_cmp_eq_u32 s51, 6
    s_cbranch_scc1 K2_OWNA6_1
    ds_write_b128 v6, v[40:43] offset:24576
K2_OWNBA6:
    s_cmp_eq_u32 s50, 7
    s_cbranch_scc1 K2_OWNA7_0
    s_cmp_eq_u32 s51, 7
    s_cbranch_scc1 K2_OWNA7_1
    ds_write_b128 v6, v[44:47] offset:28672
K2_OWNBA7:
    v_mul_u32_u24 v8, 20480, v9
    v_lshl_add_u32 v8, v10, 3, v8
    s_lshl_b32 s9, s2, 5
    v_add_u32 v8, s9, v8
    s_mul_i32 s9, s50, 327680
    s_and_b32 s54, s51, 7
    s_mul_i32 s54, s54, 327680
    v_add_u32 v118, s54, v8
    v_add_u32 v8, s9, v8
    s_lshl_b32 s52, s52, 3
    s_lshl_b32 s53, s53, 3
    s_add_u32 s52, s52, 8704
    s_add_u32 s53, s53, 8704
    s_add_u32 s9, s3, 1
    s_and_b32 s9, s9, 3
    s_lshl_b32 s9, s9, 10
    s_add_u32 s54, s9, s52
    v_add_u32 v112, s54, v4
    s_add_u32 s54, s9, s53
    v_add_u32 v115, s54, v4
    s_add_u32 s9, s3, 2
    s_and_b32 s9, s9, 3
    s_lshl_b32 s9, s9, 10
    s_add_u32 s54, s9, s52
    v_add_u32 v113, s54, v4
    s_add_u32 s54, s9, s53
    v_add_u32 v116, s54, v4
    s_add_u32 s9, s3, 3
    s_and_b32 s9, s9, 3
    s_lshl_b32 s9, s9, 10
    s_add_u32 s54, s9, s52
    v_add_u32 v114, s54, v4
    s_add_u32 s54, s9, s53
    v_add_u32 v117, s54, v4
    s_bitcmp1_b32 s2, 0
    s_cselect_b32 s24, 0, 16
    s_lshl_b32 s23, s23, s24
    s_and_b32 s23, s23, 0xffff0000
    s_add_u32 s16, s6, 7864320
    s_addc_u32 s17, s7, 0
    s_waitcnt vmcnt(1) lgkmcnt(0)
    v_cvt_f32_f16 v96, v48
    v_cvt_f32_f16_sdwa v97, v48 dst_sel:DWORD dst_unused:UNUSED_PAD src0_sel:WORD_1
    v_cvt_f32_f16 v98, v49
    v_cvt_f32_f16_sdwa v99, v49 dst_sel:DWORD dst_unused:UNUSED_PAD src0_sel:WORD_1
    v_mul_f32 v96, s23, v96
    v_mul_f32 v97, s23, v97
    v_mul_f32 v98, s23, v98
    v_mul_f32 v99, s23, v99
    v_cvt_pk_bf16_f32 v48, v96, v97
    v_cvt_pk_bf16_f32 v49, v98, v99
    v_lshlrev_b32 v96, 16, v48
    v_and_b32 v97, v15, v48
    v_lshlrev_b32 v98, 16, v49
    v_and_b32 v99, v15, v49
    v_lshlrev_b32 v104, 16, v0
    v_and_b32 v105, v15, v0
    v_lshlrev_b32 v106, 16, v1
    v_and_b32 v107, v15, v1
    s_cmp_eq_u32 s51, 15
    s_cbranch_scc1 K2_E1A
    v_cvt_f32_f16 v100, v50
    v_cvt_f32_f16_sdwa v101, v50 dst_sel:DWORD dst_unused:UNUSED_PAD src0_sel:WORD_1
    v_cvt_f32_f16 v102, v51
    v_cvt_f32_f16_sdwa v103, v51 dst_sel:DWORD dst_unused:UNUSED_PAD src0_sel:WORD_1
    v_mul_f32 v100, s23, v100
    v_mul_f32 v101, s23, v101
    v_mul_f32 v102, s23, v102
    v_mul_f32 v103, s23, v103
    v_cvt_pk_bf16_f32 v50, v100, v101
    v_cvt_pk_bf16_f32 v51, v102, v103
    v_lshlrev_b32 v100, 16, v50
    v_and_b32 v101, v15, v50
    v_lshlrev_b32 v102, 16, v51
    v_and_b32 v103, v15, v51
    v_lshlrev_b32 v108, 16, v2
    v_and_b32 v109, v15, v2
    v_lshlrev_b32 v110, 16, v3
    v_and_b32 v111, v15, v3
K2_E1A:
    s_barrier
    s_cmp_eq_u32 s3, 3
    s_cbranch_scc1 K2_FINA
    ds_read_b128 v[60:63], v112
    ds_read_b128 v[64:67], v113
    ds_read_b128 v[68:71], v114
    s_waitcnt lgkmcnt(0)
    v_pk_add_f32 v[56:57], v[56:57], v[60:61]
    v_pk_add_f32 v[58:59], v[58:59], v[62:63]
    v_pk_add_f32 v[64:65], v[64:65], v[68:69]
    v_pk_add_f32 v[66:67], v[66:67], v[70:71]
    v_pk_add_f32 v[56:57], v[56:57], v[64:65]
    v_pk_add_f32 v[58:59], v[58:59], v[66:67]
    v_mul_f32 v56, s22, v56
    v_mul_f32 v57, s22, v57
    v_mul_f32 v58, s22, v58
    v_mul_f32 v59, s22, v59
    v_cvt_pk_bf16_f32 v60, v56, v57
    v_cvt_pk_bf16_f32 v61, v58, v59
    v_lshlrev_b32 v56, 16, v60
    v_and_b32 v57, v15, v60
    v_lshlrev_b32 v58, 16, v61
    v_and_b32 v59, v15, v61
    v_pk_add_f32 v[56:57], v[56:57], v[96:97]
    v_pk_add_f32 v[58:59], v[58:59], v[98:99]
    v_cvt_pk_bf16_f32 v60, v56, v57
    v_cvt_pk_bf16_f32 v61, v58, v59
    v_lshlrev_b32 v56, 16, v60
    v_and_b32 v57, v15, v60
    v_lshlrev_b32 v58, 16, v61
    v_and_b32 v59, v15, v61
    v_pk_add_f32 v[56:57], v[56:57], v[104:105]
    v_pk_add_f32 v[58:59], v[58:59], v[106:107]
    v_cvt_pk_bf16_f32 v60, v56, v57
    v_cvt_pk_bf16_f32 v61, v58, v59
    global_store_dwordx2 v8, v[60:61], s[16:17]
K2_FINA:
    s_mov_b32 s2, s29
    s_endpgm
K2_OWNA2_0:
    s_nop 7
    v_mov_b64 v[56:57], v[24:25]
    v_mov_b64 v[58:59], v[26:27]
    s_branch K2_OWNBA2
K2_OWNA2_1:
    s_nop 7
    v_mov_b64 v[72:73], v[24:25]
    v_mov_b64 v[74:75], v[26:27]
    s_branch K2_OWNBA2
K2_OWNA6_0:
    s_nop 7
    v_mov_b64 v[56:57], v[40:41]
    v_mov_b64 v[58:59], v[42:43]
    s_branch K2_OWNBA6
K2_OWNA6_1:
    s_nop 7
    v_mov_b64 v[72:73], v[40:41]
    v_mov_b64 v[74:75], v[42:43]
    s_branch K2_OWNBA6
K2_OWNA7_0:
    s_nop 7
    v_mov_b64 v[56:57], v[44:45]
    v_mov_b64 v[58:59], v[46:47]
    s_branch K2_OWNBA7
K2_OWNA7_1:
    s_nop 7
    v_mov_b64 v[72:73], v[44:45]
    v_mov_b64 v[74:75], v[46:47]
    s_branch K2_OWNBA7
K2_VB:
    ds_read_b64 v[48:49], v12 offset:4032
    ds_read_b64 v[50:51], v12 offset:4040
    ds_read_b128 v[80:83], v13 offset:64
    ds_read_b64 v[52:53], v12 offset:3520
    ds_read_b64 v[54:55], v12 offset:3528
    ds_read_b128 v[84:87], v13 offset:576
    ds_read_b64 v[56:57], v12 offset:3008
    ds_read_b64 v[58:59], v12 offset:3016
    ds_read_b128 v[88:91], v13 offset:1088
    s_waitcnt lgkmcnt(6)
    v_mfma_f32_16x16x32_f16 v[16:19], v[48:51], v[80:83], 0
    ds_read_b64 v[60:61], v12 offset:2496
    ds_read_b64 v[62:63], v12 offset:2504
    s_waitcnt lgkmcnt(5)
    v_mfma_f32_16x16x32_f16 v[20:23], v[52:55], v[80:83], 0
    ds_read_b128 v[92:95], v13 offset:1600
    ds_read_b64 v[64:65], v12 offset:1984
    v_mfma_f32_16x16x32_f16 v[20:23], v[48:51], v[84:87], v[20:23]
    ds_read_b64 v[66:67], v12 offset:1992
    ds_read_b128 v[96:99], v13 offset:2112
    s_waitcnt lgkmcnt(6)
    v_mfma_f32_16x16x32_f16 v[28:31], v[56:59], v[84:87], 0
    ds_read_b64 v[68:69], v12 offset:1472
    ds_read_b64 v[70:71], v12 offset:1480
    v_mfma_f32_16x16x32_f16 v[32:35], v[56:59], v[88:91], 0
    ds_read_b128 v[100:103], v13 offset:2624
    ds_read_b64 v[112:113], v12 offset:3968
    v_mfma_f32_16x16x32_f16 v[28:31], v[52:55], v[88:91], v[28:31]
    ds_read_b64 v[114:115], v12 offset:3976
    ds_read_b128 v[140:143], v13 offset:0
    s_waitcnt lgkmcnt(9)
    v_mfma_f32_16x16x32_f16 v[28:31], v[60:63], v[80:83], v[28:31]
    ds_read_b64 v[116:117], v12 offset:3456
    ds_read_b64 v[118:119], v12 offset:3464
    v_mfma_f32_16x16x32_f16 v[32:35], v[60:63], v[84:87], v[32:35]
    ds_read_b128 v[144:147], v13 offset:512
    ds_read_b64 v[120:121], v12 offset:2944
    v_mfma_f32_16x16x32_f16 v[36:39], v[60:63], v[88:91], 0
    ds_read_b64 v[122:123], v12 offset:2952
    ds_read_b128 v[148:151], v13 offset:1024
    v_mfma_f32_16x16x32_f16 v[28:31], v[48:51], v[92:95], v[28:31]
    ds_read_b64 v[124:125], v12 offset:2432
    ds_read_b64 v[126:127], v12 offset:2440
    v_mfma_f32_16x16x32_f16 v[32:35], v[52:55], v[92:95], v[32:35]
    ds_read_b128 v[152:155], v13 offset:1536
    ds_read_b64 v[128:129], v12 offset:1920
    v_mfma_f32_16x16x32_f16 v[36:39], v[56:59], v[92:95], v[36:39]
    ds_read_b64 v[130:131], v12 offset:1928
    ds_read_b128 v[156:159], v13 offset:2048
    s_waitcnt lgkmcnt(15)
    v_mfma_f32_16x16x32_f16 v[32:35], v[64:67], v[80:83], v[32:35]
    ds_read_b64 v[132:133], v12 offset:1408
    ds_read_b64 v[134:135], v12 offset:1416
    v_mfma_f32_16x16x32_f16 v[36:39], v[64:67], v[84:87], v[36:39]
    ds_read_b128 v[160:163], v13 offset:2560
    v_mfma_f32_16x16x32_f16 v[32:35], v[48:51], v[96:99], v[32:35]
    v_mfma_f32_16x16x32_f16 v[36:39], v[52:55], v[96:99], v[36:39]
    s_waitcnt lgkmcnt(15)
    v_mfma_f32_16x16x32_f16 v[36:39], v[68:71], v[80:83], v[36:39]
    v_mfma_f32_16x16x32_f16 v[36:39], v[48:51], v[100:103], v[36:39]
    s_waitcnt lgkmcnt(15)
    v_mfma_f32_16x16x32_f16 v[16:19], v[112:115], v[140:143], v[16:19]
    s_waitcnt lgkmcnt(12)
    v_mfma_f32_16x16x32_f16 v[20:23], v[116:119], v[140:143], v[20:23]
    v_mfma_f32_16x16x32_f16 v[20:23], v[112:115], v[144:147], v[20:23]
    s_waitcnt lgkmcnt(9)
    v_mfma_f32_16x16x32_f16 v[28:31], v[120:123], v[144:147], v[28:31]
    v_mfma_f32_16x16x32_f16 v[32:35], v[120:123], v[148:151], v[32:35]
    v_mfma_f32_16x16x32_f16 v[28:31], v[116:119], v[148:151], v[28:31]
    s_waitcnt lgkmcnt(6)
    v_mfma_f32_16x16x32_f16 v[28:31], v[124:127], v[140:143], v[28:31]
    v_mfma_f32_16x16x32_f16 v[32:35], v[124:127], v[144:147], v[32:35]
    v_mfma_f32_16x16x32_f16 v[36:39], v[124:127], v[148:151], v[36:39]
    v_mfma_f32_16x16x32_f16 v[28:31], v[112:115], v[152:155], v[28:31]
    v_mfma_f32_16x16x32_f16 v[32:35], v[116:119], v[152:155], v[32:35]
    v_mfma_f32_16x16x32_f16 v[36:39], v[120:123], v[152:155], v[36:39]
    s_waitcnt lgkmcnt(3)
    v_mfma_f32_16x16x32_f16 v[32:35], v[128:131], v[140:143], v[32:35]
    v_mfma_f32_16x16x32_f16 v[36:39], v[128:131], v[144:147], v[36:39]
    v_mfma_f32_16x16x32_f16 v[32:35], v[112:115], v[156:159], v[32:35]
    v_mfma_f32_16x16x32_f16 v[36:39], v[116:119], v[156:159], v[36:39]
    s_waitcnt lgkmcnt(0)
    v_mfma_f32_16x16x32_f16 v[36:39], v[132:135], v[140:143], v[36:39]
    v_mfma_f32_16x16x32_f16 v[36:39], v[112:115], v[160:163], v[36:39]
    s_setprio 0
    s_lshl_b32 s9, s3, 10
    s_add_u32 s9, s9, 8704
    v_add_u32 v6, s9, v4
    s_lshl_b32 s52, s50, 9
    s_and_b32 s53, s51, 7
    s_lshl_b32 s53, s53, 9
    v_add_u32 v7, s52, v14
    v_add_u32 v11, s53, v14
    ds_read_b64 v[48:49], v7 offset:512
    ds_read_b64 v[50:51], v11 offset:512
    s_barrier
    s_cmp_eq_u32 s50, 0
    s_cbranch_scc1 K2_OWNB0_0
    s_cmp_eq_u32 s51, 0
    s_cbranch_scc1 K2_OWNB0_1
    ds_write_b128 v6, v[16:19] offset:0
K2_OWNBB0:
    s_cmp_eq_u32 s50, 1
    s_cbranch_scc1 K2_OWNB1_0
    s_cmp_eq_u32 s51, 1
    s_cbranch_scc1 K2_OWNB1_1
    ds_write_b128 v6, v[20:23] offset:4096
K2_OWNBB1:
    s_cmp_eq_u32 s50, 3
    s_cbranch_scc1 K2_OWNB3_0
    s_cmp_eq_u32 s51, 3
    s_cbranch_scc1 K2_OWNB3_1
    ds_write_b128 v6, v[28:31] offset:12288
K2_OWNBB3:
    s_cmp_eq_u32 s50, 4
    s_cbranch_scc1 K2_OWNB4_0
    s_cmp_eq_u32 s51, 4
    s_cbranch_scc1 K2_OWNB4_1
    ds_write_b128 v6, v[32:35] offset:16384
K2_OWNBB4:
    s_cmp_eq_u32 s50, 5
    s_cbranch_scc1 K2_OWNB5_0
    s_cmp_eq_u32 s51, 5
    s_cbranch_scc1 K2_OWNB5_1
    ds_write_b128 v6, v[36:39] offset:20480
K2_OWNBB5:
    v_mul_u32_u24 v8, 20480, v9
    v_lshl_add_u32 v8, v10, 3, v8
    s_lshl_b32 s9, s2, 5
    v_add_u32 v8, s9, v8
    s_mul_i32 s9, s50, 327680
    s_and_b32 s54, s51, 7
    s_mul_i32 s54, s54, 327680
    v_add_u32 v118, s54, v8
    v_add_u32 v8, s9, v8
    s_lshl_b32 s52, s52, 3
    s_lshl_b32 s53, s53, 3
    s_add_u32 s52, s52, 8704
    s_add_u32 s53, s53, 8704
    s_add_u32 s9, s3, 1
    s_and_b32 s9, s9, 3
    s_lshl_b32 s9, s9, 10
    s_add_u32 s54, s9, s52
    v_add_u32 v112, s54, v4
    s_add_u32 s54, s9, s53
    v_add_u32 v115, s54, v4
    s_add_u32 s9, s3, 2
    s_and_b32 s9, s9, 3
    s_lshl_b32 s9, s9, 10
    s_add_u32 s54, s9, s52
    v_add_u32 v113, s54, v4
    s_add_u32 s54, s9, s53
    v_add_u32 v116, s54, v4
    s_add_u32 s9, s3, 3
    s_and_b32 s9, s9, 3
    s_lshl_b32 s9, s9, 10
    s_add_u32 s54, s9, s52
    v_add_u32 v114, s54, v4
    s_add_u32 s54, s9, s53
    v_add_u32 v117, s54, v4
    s_bitcmp1_b32 s2, 0
    s_cselect_b32 s24, 0, 16
    s_lshl_b32 s23, s23, s24
    s_and_b32 s23, s23, 0xffff0000
    s_add_u32 s16, s6, 7864320
    s_addc_u32 s17, s7, 0
    s_waitcnt vmcnt(1) lgkmcnt(0)
    v_cvt_f32_f16 v96, v48
    v_cvt_f32_f16_sdwa v97, v48 dst_sel:DWORD dst_unused:UNUSED_PAD src0_sel:WORD_1
    v_cvt_f32_f16 v98, v49
    v_cvt_f32_f16_sdwa v99, v49 dst_sel:DWORD dst_unused:UNUSED_PAD src0_sel:WORD_1
    v_mul_f32 v96, s23, v96
    v_mul_f32 v97, s23, v97
    v_mul_f32 v98, s23, v98
    v_mul_f32 v99, s23, v99
    v_cvt_pk_bf16_f32 v48, v96, v97
    v_cvt_pk_bf16_f32 v49, v98, v99
    v_lshlrev_b32 v96, 16, v48
    v_and_b32 v97, v15, v48
    v_lshlrev_b32 v98, 16, v49
    v_and_b32 v99, v15, v49
    v_lshlrev_b32 v104, 16, v0
    v_and_b32 v105, v15, v0
    v_lshlrev_b32 v106, 16, v1
    v_and_b32 v107, v15, v1
    s_cmp_eq_u32 s51, 15
    s_cbranch_scc1 K2_E1B
    v_cvt_f32_f16 v100, v50
    v_cvt_f32_f16_sdwa v101, v50 dst_sel:DWORD dst_unused:UNUSED_PAD src0_sel:WORD_1
    v_cvt_f32_f16 v102, v51
    v_cvt_f32_f16_sdwa v103, v51 dst_sel:DWORD dst_unused:UNUSED_PAD src0_sel:WORD_1
    v_mul_f32 v100, s23, v100
    v_mul_f32 v101, s23, v101
    v_mul_f32 v102, s23, v102
    v_mul_f32 v103, s23, v103
    v_cvt_pk_bf16_f32 v50, v100, v101
    v_cvt_pk_bf16_f32 v51, v102, v103
    v_lshlrev_b32 v100, 16, v50
    v_and_b32 v101, v15, v50
    v_lshlrev_b32 v102, 16, v51
    v_and_b32 v103, v15, v51
    v_lshlrev_b32 v108, 16, v2
    v_and_b32 v109, v15, v2
    v_lshlrev_b32 v110, 16, v3
    v_and_b32 v111, v15, v3
K2_E1B:
    s_barrier
    ds_read_b128 v[60:63], v112
    ds_read_b128 v[64:67], v113
    ds_read_b128 v[68:71], v114
    s_waitcnt lgkmcnt(0)
    v_pk_add_f32 v[56:57], v[56:57], v[60:61]
    v_pk_add_f32 v[58:59], v[58:59], v[62:63]
    v_pk_add_f32 v[64:65], v[64:65], v[68:69]
    v_pk_add_f32 v[66:67], v[66:67], v[70:71]
    v_pk_add_f32 v[56:57], v[56:57], v[64:65]
    v_pk_add_f32 v[58:59], v[58:59], v[66:67]
    v_mul_f32 v56, s22, v56
    v_mul_f32 v57, s22, v57
    v_mul_f32 v58, s22, v58
    v_mul_f32 v59, s22, v59
    v_cvt_pk_bf16_f32 v60, v56, v57
    v_cvt_pk_bf16_f32 v61, v58, v59
    v_lshlrev_b32 v56, 16, v60
    v_and_b32 v57, v15, v60
    v_lshlrev_b32 v58, 16, v61
    v_and_b32 v59, v15, v61
    v_pk_add_f32 v[56:57], v[56:57], v[96:97]
    v_pk_add_f32 v[58:59], v[58:59], v[98:99]
    v_cvt_pk_bf16_f32 v60, v56, v57
    v_cvt_pk_bf16_f32 v61, v58, v59
    v_lshlrev_b32 v56, 16, v60
    v_and_b32 v57, v15, v60
    v_lshlrev_b32 v58, 16, v61
    v_and_b32 v59, v15, v61
    v_pk_add_f32 v[56:57], v[56:57], v[104:105]
    v_pk_add_f32 v[58:59], v[58:59], v[106:107]
    v_cvt_pk_bf16_f32 v60, v56, v57
    v_cvt_pk_bf16_f32 v61, v58, v59
    global_store_dwordx2 v8, v[60:61], s[16:17]
    s_cmp_eq_u32 s51, 15
    s_cbranch_scc1 K2_FINB
    ds_read_b128 v[76:79], v115
    ds_read_b128 v[80:83], v116
    ds_read_b128 v[84:87], v117
    s_waitcnt lgkmcnt(0)
    v_pk_add_f32 v[72:73], v[72:73], v[76:77]
    v_pk_add_f32 v[74:75], v[74:75], v[78:79]
    v_pk_add_f32 v[80:81], v[80:81], v[84:85]
    v_pk_add_f32 v[82:83], v[82:83], v[86:87]
    v_pk_add_f32 v[72:73], v[72:73], v[80:81]
    v_pk_add_f32 v[74:75], v[74:75], v[82:83]
    v_mul_f32 v72, s22, v72
    v_mul_f32 v73, s22, v73
    v_mul_f32 v74, s22, v74
    v_mul_f32 v75, s22, v75
    v_cvt_pk_bf16_f32 v76, v72, v73
    v_cvt_pk_bf16_f32 v77, v74, v75
    v_lshlrev_b32 v72, 16, v76
    v_and_b32 v73, v15, v76
    v_lshlrev_b32 v74, 16, v77
    v_and_b32 v75, v15, v77
    v_pk_add_f32 v[72:73], v[72:73], v[100:101]
    v_pk_add_f32 v[74:75], v[74:75], v[102:103]
    v_cvt_pk_bf16_f32 v76, v72, v73
    v_cvt_pk_bf16_f32 v77, v74, v75
    v_lshlrev_b32 v72, 16, v76
    v_and_b32 v73, v15, v76
    v_lshlrev_b32 v74, 16, v77
    v_and_b32 v75, v15, v77
    v_pk_add_f32 v[72:73], v[72:73], v[108:109]
    v_pk_add_f32 v[74:75], v[74:75], v[110:111]
    v_cvt_pk_bf16_f32 v76, v72, v73
    v_cvt_pk_bf16_f32 v77, v74, v75
    global_store_dwordx2 v118, v[76:77], s[16:17]
K2_FINB:
    s_mov_b32 s2, s29
    s_endpgm
K2_OWNB0_0:
    s_nop 7
    v_mov_b64 v[56:57], v[16:17]
    v_mov_b64 v[58:59], v[18:19]
    s_branch K2_OWNBB0
K2_OWNB0_1:
    s_nop 7
    v_mov_b64 v[72:73], v[16:17]
    v_mov_b64 v[74:75], v[18:19]
    s_branch K2_OWNBB0
K2_OWNB1_0:
    s_nop 7
    v_mov_b64 v[56:57], v[20:21]
    v_mov_b64 v[58:59], v[22:23]
    s_branch K2_OWNBB1
K2_OWNB1_1:
    s_nop 7
    v_mov_b64 v[72:73], v[20:21]
    v_mov_b64 v[74:75], v[22:23]
    s_branch K2_OWNBB1
K2_OWNB3_0:
    s_nop 7
    v_mov_b64 v[56:57], v[28:29]
    v_mov_b64 v[58:59], v[30:31]
    s_branch K2_OWNBB3
K2_OWNB3_1:
    s_nop 7
    v_mov_b64 v[72:73], v[28:29]
    v_mov_b64 v[74:75], v[30:31]
    s_branch K2_OWNBB3
K2_OWNB4_0:
    s_nop 7
    v_mov_b64 v[56:57], v[32:33]
    v_mov_b64 v[58:59], v[34:35]
    s_branch K2_OWNBB4
K2_OWNB4_1:
    s_nop 7
    v_mov_b64 v[72:73], v[32:33]
    v_mov_b64 v[74:75], v[34:35]
    s_branch K2_OWNBB4
K2_OWNB5_0:
    s_nop 7
    v_mov_b64 v[56:57], v[36:37]
    v_mov_b64 v[58:59], v[38:39]
    s_branch K2_OWNBB5
K2_OWNB5_1:
    s_nop 7
    v_mov_b64 v[72:73], v[36:37]
    v_mov_b64 v[74:75], v[38:39]
    s_branch K2_OWNBB5
K2_END:
    s_endpgm
.p2align 8
.globl kb_kernel
.type kb_kernel,@function
kb_kernel:
    s_cmp_ge_u32 s2, 222
    s_cbranch_scc1 KB_END
    s_load_dwordx2 s[6:7], s[0:1], 112
    s_cmp_ge_u32 s2, 182
    s_cbranch_scc1 KB_D
    s_cmp_ge_u32 s2, 128
    s_cbranch_scc1 KB_G
    s_load_dwordx2 s[8:9], s[0:1], 64
    s_load_dwordx2 s[10:11], s[0:1], 96
    s_lshl_b32 s13, s2, 4
    v_and_b32 v1, 15, v0
    v_bfe_u32 v2, v0, 4, 2
    v_lshrrev_b32 v3, 6, v0
    v_lshlrev_b32 v4, 6, v3
    v_lshrrev_b32 v5, 2, v1
    v_and_b32 v6, 3, v1
    v_lshl_add_u32 v5, v5, 3, v6
    v_add_u32 v5, v5, v4
    v_lshlrev_b32 v5, 5, v5
    v_lshl_add_u32 v5, v2, 3, v5
    s_mul_i32 s14, s2, 20480
    s_add_u32 s14, s14, 7864320
    v_add_u32 v5, s14, v5
    v_lshl_add_u32 v6, v2, 3, v4
    v_lshlrev_b32 v6, 1, v6
    v_add_u32 v7, s13, v1
    v_mul_u32_u24 v7, 1280, v7
    v_add_u32 v7, v7, v6
    s_waitcnt lgkmcnt(0)
    global_load_dwordx2 v[16:17], v5, s[6:7]
    global_load_dwordx2 v[18:19], v5, s[6:7] offset:128
    global_load_dwordx2 v[20:21], v5, s[6:7] offset:1024
    global_load_dwordx2 v[22:23], v5, s[6:7] offset:1152
    global_load_dwordx4 v[24:27], v6, s[8:9]
    global_load_dwordx4 v[28:31], v6, s[8:9] offset:64
    v_lshlrev_b32 v8, 2, v2
    v_sub_u32 v8, v1, v8
    v_and_b32 v9, 1, v1
    v_lshlrev_b32 v9, 4, v9
    v_mov_b32 v10, 0x3f80
    v_lshlrev_b32 v9, v9, v10
    v_ashrrev_i32 v8, 1, v8
    v_cmp_eq_u32 vcc, 0, v8
    s_nop 1
    v_cndmask_b32 v32, 0, v9, vcc
    v_cmp_eq_u32 vcc, 1, v8
    s_nop 1
    v_cndmask_b32 v33, 0, v9, vcc
    v_mov_b32 v15, 0xffff0000
    v_lshlrev_b32 v10, 6, v0
    v_and_b32 v10, 0xfc0, v10
    v_lshl_add_u32 v11, v3, 2, v10
    v_add_u32 v9, s13, v1
    v_sub_u32 v9, 0xffff, v9
    s_lshl_b32 s14, s2, 7
    v_lshl_add_u32 v8, v0, 3, s14
    v_readfirstlane_b32 s4, v3
    s_add_u32 s16, s6, 10944512
    s_addc_u32 s17, s7, 0
    s_add_u32 s18, s6, 10977280
    s_addc_u32 s19, s7, 0
    s_waitcnt vmcnt(5)
    v_mfma_f32_16x16x16_bf16 v[40:43], v[16:17], v[32:33], 0
    s_waitcnt vmcnt(4)
    v_mfma_f32_16x16x16_bf16 v[44:47], v[18:19], v[32:33], 0
    s_waitcnt vmcnt(3)
    v_mfma_f32_16x16x16_bf16 v[48:51], v[20:21], v[32:33], 0
    s_waitcnt vmcnt(2)
    v_mfma_f32_16x16x16_bf16 v[52:55], v[22:23], v[32:33], 0
    s_waitcnt vmcnt(0)
    v_lshlrev_b32 v56, 16, v24
    v_and_b32 v57, v15, v24
    v_lshlrev_b32 v58, 16, v25
    v_and_b32 v59, v15, v25
    v_lshlrev_b32 v60, 16, v26
    v_and_b32 v61, v15, v26
    v_lshlrev_b32 v62, 16, v27
    v_and_b32 v63, v15, v27
    v_lshlrev_b32 v64, 16, v28
    v_and_b32 v65, v15, v28
    v_lshlrev_b32 v66, 16, v29
    v_and_b32 v67, v15, v29
    v_lshlrev_b32 v68, 16, v30
    v_and_b32 v69, v15, v30
    v_lshlrev_b32 v70, 16, v31
    v_and_b32 v71, v15, v31
    v_pk_add_f32 v[36:37], v[56:57], v[58:59]
    v_pk_add_f32 v[38:39], v[60:61], v[62:63]
    v_pk_mul_f32 v[12:13], v[40:41], v[40:41]
    v_pk_mul_f32 v[34:35], v[40:41], v[56:57]
    v_pk_add_f32 v[16:17], v[40:41], v[42:43]
    v_pk_add_f32 v[36:37], v[36:37], v[64:65]
    v_pk_add_f32 v[38:39], v[38:39], v[66:67]
    v_pk_fma_f32 v[12:13], v[42:43], v[42:43], v[12:13]
    v_pk_fma_f32 v[34:35], v[42:43], v[58:59], v[34:35]
    v_pk_fma_f32 v[12:13], v[44:45], v[44:45], v[12:13]
    v_pk_fma_f32 v[34:35], v[44:45], v[60:61], v[34:35]
    v_pk_add_f32 v[16:17], v[16:17], v[44:45]
    v_pk_fma_f32 v[12:13], v[46:47], v[46:47], v[12:13]
    v_pk_fma_f32 v[34:35], v[46:47], v[62:63], v[34:35]
    v_pk_add_f32 v[16:17], v[16:17], v[46:47]
    v_pk_fma_f32 v[12:13], v[48:49], v[48:49], v[12:13]
    v_pk_fma_f32 v[34:35], v[48:49], v[64:65], v[34:35]
    v_pk_add_f32 v[16:17], v[16:17], v[48:49]
    v_pk_fma_f32 v[12:13], v[50:51], v[50:51], v[12:13]
    v_pk_fma_f32 v[34:35], v[50:51], v[66:67], v[34:35]
    v_pk_add_f32 v[16:17], v[16:17], v[50:51]
    v_pk_fma_f32 v[12:13], v[52:53], v[52:53], v[12:13]
    v_pk_fma_f32 v[34:35], v[52:53], v[68:69], v[34:35]
    v_pk_add_f32 v[16:17], v[16:17], v[52:53]
    v_pk_fma_f32 v[12:13], v[54:55], v[54:55], v[12:13]
    v_pk_fma_f32 v[34:35], v[54:55], v[70:71], v[34:35]
    v_pk_add_f32 v[16:17], v[16:17], v[54:55]
    v_pk_add_f32 v[36:37], v[36:37], v[68:69]
    v_pk_add_f32 v[38:39], v[38:39], v[70:71]
    v_pk_add_f32 v[36:37], v[36:37], v[38:39]
    v_add_f32 v16, v16, v17
    v_add_f32 v12, v12, v13
    v_add_f32 v34, v34, v35
    v_add_f32 v36, v36, v37
    v_permlane32_swap_b32 v16, v12
    s_nop 0
    v_permlane32_swap_b32 v34, v36
    v_add_f32 v16, v16, v12
    v_add_f32 v34, v34, v36
    s_nop 1
    v_permlane16_swap_b32 v16, v34
    v_add_f32 v16, v16, v34
    ds_write_b32 v11, v16
    s_waitcnt lgkmcnt(0)
    s_barrier
    ds_read_b128 v[56:59], v10
    ds_read_b128 v[60:63], v10 offset:16
    ds_read_b64 v[64:65], v10 offset:32
    s_waitcnt lgkmcnt(0)
    v_pk_add_f32 v[56:57], v[56:57], v[58:59]
    v_pk_add_f32 v[60:61], v[60:61], v[62:63]
    v_pk_add_f32 v[56:57], v[56:57], v[64:65]
    v_pk_add_f32 v[56:57], v[56:57], v[60:61]
    v_add_f32 v56, v56, v57
    v_mov_b32 v36, v56
    s_nop 1
    v_permlane32_swap_b32 v56, v36
    v_mov_b32 v34, v56
    v_mov_b32 v35, v36
    s_nop 0
    v_permlane16_swap_b32 v56, v34
    v_permlane16_swap_b32 v36, v35
    v_mul_f32 v56, 0x3acccccd, v56
    v_mul_f32 v36, 0x3acccccd, v36
    v_fma_f32 v36, -v56, v56, v36
    v_max_f32 v36, 0, v36
    v_cvt_pk_bf16_f32 v12, v56, v56
    v_lshlrev_b32 v12, 16, v12
    v_cvt_pk_bf16_f32 v36, v36, v36
    v_lshlrev_b32 v36, 16, v36
    v_add_f32 v36, 0x3727c5ac, v36
    v_cvt_pk_bf16_f32 v36, v36, v36
    v_lshlrev_b32 v36, 16, v36
    v_sqrt_f32 v36, v36
    s_nop 0
    v_cvt_pk_bf16_f32 v36, v36, v36
    v_lshlrev_b32 v36, 16, v36
    v_rcp_f32 v13, v36
    s_cmp_lg_u32 s4, 0
    s_cbranch_scc1 KB_NOKEY
    v_fma_f32 v64, -v12, v35, v34
    v_lshrrev_b32 v65, 16, v12
    v_mul_f32 v64, v64, v13
    v_or_b32 v65, v65, v36
    v_cvt_pk_bf16_f32 v64, v64, v64
    v_and_b32 v64, 0xffff, v64
    v_xor_b32 v66, 0xffff, v64
    v_or_b32 v67, 0x8000, v64
    v_cmp_lt_u32 vcc, 0x7fff, v64
    s_nop 1
    v_cndmask_b32 v64, v67, v66, vcc
    v_lshl_or_b32 v64, v64, 16, v9
    s_nop 1
    v_max_u32_dpp v66, v64, v64 row_ror:8 row_mask:0xf bank_mask:0xf
    s_nop 1
    v_max_u32_dpp v66, v66, v66 row_ror:4 row_mask:0xf bank_mask:0xf
    s_nop 1
    v_max_u32_dpp v66, v66, v66 row_ror:2 row_mask:0xf bank_mask:0xf
    s_nop 1
    v_max_u32_dpp v66, v66, v66 row_ror:1 row_mask:0xf bank_mask:0xf
    v_cmp_eq_u32 vcc, v64, v66
    s_nop 1
    v_cndmask_b32 v67, 0, v65, vcc
    s_nop 1
    v_max_u32_dpp v67, v67, v67 row_ror:8 row_mask:0xf bank_mask:0xf
    s_nop 1
    v_max_u32_dpp v67, v67, v67 row_ror:4 row_mask:0xf bank_mask:0xf
    s_nop 1
    v_max_u32_dpp v67, v67, v67 row_ror:2 row_mask:0xf bank_mask:0xf
    s_nop 1
    v_max_u32_dpp v67, v67, v67 row_ror:1 row_mask:0xf bank_mask:0xf
    v_cmp_gt_u32 vcc, 16, v0
    s_nop 1
    s_and_saveexec_b64 s[22:23], vcc
    global_store_dwordx2 v8, v[66:67], s[16:17] sc1
    s_mov_b64 exec, s[22:23]
KB_NOKEY:
    v_sub_f32 v56, v40, v12
    v_sub_f32 v57, v41, v12
    v_cvt_pk_bf16_f32 v58, v56, v57
    v_lshlrev_b32 v56, 16, v58
    v_and_b32 v57, v15, v58
    v_mul_f32 v56, v56, v13
    v_mul_f32 v57, v57, v13
    v_cvt_pk_bf16_f32 v58, v56, v57
    v_lshlrev_b32 v56, 16, v58
    v_and_b32 v57, v15, v58
    v_add_f32 v56, v56, v40
    v_add_f32 v57, v57, v41
    v_cvt_pk_bf16_f32 v24, v56, v57
    v_sub_f32 v60, v42, v12
    v_sub_f32 v61, v43, v12
    v_cvt_pk_bf16_f32 v62, v60, v61
    v_lshlrev_b32 v60, 16, v62
    v_and_b32 v61, v15, v62
    v_mul_f32 v60, v60, v13
    v_mul_f32 v61, v61, v13
    v_cvt_pk_bf16_f32 v62, v60, v61
    v_lshlrev_b32 v60, 16, v62
    v_and_b32 v61, v15, v62
    v_add_f32 v60, v60, v42
    v_add_f32 v61, v61, v43
    v_cvt_pk_bf16_f32 v25, v60, v61
    v_sub_f32 v56, v44, v12
    v_sub_f32 v57, v45, v12
    v_cvt_pk_bf16_f32 v58, v56, v57
    v_lshlrev_b32 v56, 16, v58
    v_and_b32 v57, v15, v58
    v_mul_f32 v56, v56, v13
    v_mul_f32 v57, v57, v13
    v_cvt_pk_bf16_f32 v58, v56, v57
    v_lshlrev_b32 v56, 16, v58
    v_and_b32 v57, v15, v58
    v_add_f32 v56, v56, v44
    v_add_f32 v57, v57, v45
    v_cvt_pk_bf16_f32 v26, v56, v57
    v_sub_f32 v60, v46, v12
    v_sub_f32 v61, v47, v12
    v_cvt_pk_bf16_f32 v62, v60, v61
    v_lshlrev_b32 v60, 16, v62
    v_and_b32 v61, v15, v62
    v_mul_f32 v60, v60, v13
    v_mul_f32 v61, v61, v13
    v_cvt_pk_bf16_f32 v62, v60, v61
    v_lshlrev_b32 v60, 16, v62
    v_and_b32 v61, v15, v62
    v_add_f32 v60, v60, v46
    v_add_f32 v61, v61, v47
    v_cvt_pk_bf16_f32 v27, v60, v61
    v_sub_f32 v56, v48, v12
    v_sub_f32 v57, v49, v12
    v_cvt_pk_bf16_f32 v58, v56, v57
    v_lshlrev_b32 v56, 16, v58
    v_and_b32 v57, v15, v58
    v_mul_f32 v56, v56, v13
    v_mul_f32 v57, v57, v13
    v_cvt_pk_bf16_f32 v58, v56, v57
    v_lshlrev_b32 v56, 16, v58
    v_and_b32 v57, v15, v58
    v_add_f32 v56, v56, v48
    v_add_f32 v57, v57, v49
    v_cvt_pk_bf16_f32 v28, v56, v57
    v_sub_f32 v60, v50, v12
    v_sub_f32 v61, v51, v12
    v_cvt_pk_bf16_f32 v62, v60, v61
    v_lshlrev_b32 v60, 16, v62
    v_and_b32 v61, v15, v62
    v_mul_f32 v60, v60, v13
    v_mul_f32 v61, v61, v13
    v_cvt_pk_bf16_f32 v62, v60, v61
    v_lshlrev_b32 v60, 16, v62
    v_and_b32 v61, v15, v62
    v_add_f32 v60, v60, v50
    v_add_f32 v61, v61, v51
    v_cvt_pk_bf16_f32 v29, v60, v61
    v_sub_f32 v56, v52, v12
    v_sub_f32 v57, v53, v12
    v_cvt_pk_bf16_f32 v58, v56, v57
    v_lshlrev_b32 v56, 16, v58
    v_and_b32 v57, v15, v58
    v_mul_f32 v56, v56, v13
    v_mul_f32 v57, v57, v13
    v_cvt_pk_bf16_f32 v58, v56, v57
    v_lshlrev_b32 v56, 16, v58
    v_and_b32 v57, v15, v58
    v_add_f32 v56, v56, v52
    v_add_f32 v57, v57, v53
    v_cvt_pk_bf16_f32 v30, v56, v57
    v_sub_f32 v60, v54, v12
    v_sub_f32 v61, v55, v12
    v_cvt_pk_bf16_f32 v62, v60, v61
    v_lshlrev_b32 v60, 16, v62
    v_and_b32 v61, v15, v62
    v_mul_f32 v60, v60, v13
    v_mul_f32 v61, v61, v13
    v_cvt_pk_bf16_f32 v62, v60, v61
    v_lshlrev_b32 v60, 16, v62
    v_and_b32 v61, v15, v62
    v_add_f32 v60, v60, v54
    v_add_f32 v61, v61, v55
    v_cvt_pk_bf16_f32 v31, v60, v61
    s_waitcnt vmcnt(0)
    s_barrier
    global_store_dwordx4 v7, v[24:27], s[10:11] sc1
    global_store_dwordx4 v7, v[28:31], s[10:11] offset:64 sc1
    s_waitcnt vmcnt(0)
    s_barrier
    v_cmp_gt_u32 vcc, 16, v0
    s_nop 1
    s_and_saveexec_b64 s[22:23], vcc
    s_cbranch_execz KB_END
    global_store_dwordx2 v8, v[66:67], s[18:19] sc1
    s_endpgm
KB_G:
    s_load_dwordx4 s[8:11], s[0:1], 72
    s_sub_u32 s12, s2, 128
    s_and_b32 s13, s12, 7
    s_lshr_b32 s12, s12, 3
    s_mul_i32 s3, s13, 7
    s_add_u32 s12, s12, s3
    s_cmp_eq_u32 s13, 7
    s_cselect_b32 s3, 1, 0
    s_sub_u32 s12, s12, s3
    s_lshl_b32 s13, s12, 6
    v_and_b32 v1, 15, v0
    v_bfe_u32 v2, v0, 4, 2
    v_lshrrev_b32 v3, 6, v0
    v_lshrrev_b32 v4, 2, v1
    v_and_b32 v5, 3, v1
    v_lshl_add_u32 v4, v4, 3, v5
    v_lshl_add_u32 v4, v3, 6, v4
    v_mul_u32_u24 v4, 3456, v4
    v_lshl_add_u32 v4, v2, 4, v4
    v_add_u32 v4, s13, v4
    v_lshlrev_b32 v5, 5, v0
    v_mov_b32 v6, 0
    v_readfirstlane_b32 s4, v3
    v_lshlrev_b32 v9, 7, v3
    v_lshl_add_u32 v9, v2, 4, v9
    v_lshlrev_b32 v11, 1, v0
    v_mul_u32_u24 v10, 48, v1
    v_lshl_add_u32 v10, v3, 2, v10
    v_mul_u32_u24 v7, 48, v0
    s_mov_b32 s26, 0x07060302
    s_waitcnt lgkmcnt(0)
    global_load_dwordx4 v[16:19], v4, s[8:9]
    global_load_dwordx4 v[32:35], v4, s[10:11]
    v_add_u32 v4, 13824, v4
    global_load_dwordx4 v[20:23], v4, s[8:9]
    global_load_dwordx4 v[36:39], v4, s[10:11]
    v_add_u32 v4, 96768, v4
    global_load_dwordx4 v[24:27], v4, s[8:9]
    global_load_dwordx4 v[40:43], v4, s[10:11]
    v_add_u32 v4, 13824, v4
    global_load_dwordx4 v[28:31], v4, s[8:9]
    global_load_dwordx4 v[44:47], v4, s[10:11]
    s_add_u32 s16, s6, 10944512
    s_addc_u32 s17, s7, 0
    s_add_u32 s14, s6, 10960896
    s_addc_u32 s15, s7, 0
    v_lshlrev_b32 v12, 3, v2
    v_sub_u32 v12, v1, v12
    v_add_u32 v13, 16, v12
    v_and_b32 v14, 1, v1
    v_lshlrev_b32 v14, 4, v14
    v_mov_b32 v15, 0x3f80
    v_lshlrev_b32 v14, v14, v15
    v_ashrrev_i32 v12, 1, v12
    v_ashrrev_i32 v13, 1, v13
    v_cmp_eq_u32 vcc, 0, v12
    s_nop 1
    v_cndmask_b32 v48, 0, v14, vcc
    v_cmp_eq_u32 vcc, 0, v13
    s_nop 1
    v_cndmask_b32 v52, 0, v14, vcc
    v_cmp_eq_u32 vcc, 1, v12
    s_nop 1
    v_cndmask_b32 v49, 0, v14, vcc
    v_cmp_eq_u32 vcc, 1, v13
    s_nop 1
    v_cndmask_b32 v53, 0, v14, vcc
    v_cmp_eq_u32 vcc, 2, v12
    s_nop 1
    v_cndmask_b32 v50, 0, v14, vcc
    v_cmp_eq_u32 vcc, 2, v13
    s_nop 1
    v_cndmask_b32 v54, 0, v14, vcc
    v_cmp_eq_u32 vcc, 3, v12
    s_nop 1
    v_cndmask_b32 v51, 0, v14, vcc
    v_cmp_eq_u32 vcc, 3, v13
    s_nop 1
    v_cndmask_b32 v55, 0, v14, vcc
    s_waitcnt vmcnt(0)
    v_mfma_f32_16x16x32_bf16 v[56:59], v[16:19], v[48:51], 0
    v_mfma_f32_16x16x32_bf16 v[60:63], v[20:23], v[48:51], 0
    v_mfma_f32_16x16x32_bf16 v[64:67], v[16:19], v[52:55], 0
    v_mfma_f32_16x16x32_bf16 v[68:71], v[20:23], v[52:55], 0
    s_nop 4
    v_perm_b32 v72, v57, v56, s26
    v_perm_b32 v73, v59, v58, s26
    v_perm_b32 v74, v61, v60, s26
    v_perm_b32 v75, v63, v62, s26
    v_perm_b32 v76, v65, v64, s26
    v_perm_b32 v77, v67, v66, s26
    v_perm_b32 v78, v69, v68, s26
    v_perm_b32 v79, v71, v70, s26
    v_mfma_f32_16x16x32_bf16 v[56:59], v[24:27], v[48:51], 0
    v_mfma_f32_16x16x32_bf16 v[60:63], v[28:31], v[48:51], 0
    v_mfma_f32_16x16x32_bf16 v[64:67], v[24:27], v[52:55], 0
    v_mfma_f32_16x16x32_bf16 v[68:71], v[28:31], v[52:55], 0
    s_nop 4
    v_perm_b32 v80, v57, v56, s26
    v_perm_b32 v81, v59, v58, s26
    v_perm_b32 v82, v61, v60, s26
    v_perm_b32 v83, v63, v62, s26
    v_perm_b32 v84, v65, v64, s26
    v_perm_b32 v85, v67, v66, s26
    v_perm_b32 v86, v69, v68, s26
    v_perm_b32 v87, v71, v70, s26
    v_mfma_f32_16x16x32_bf16 v[56:59], v[32:35], v[48:51], 0
    v_mfma_f32_16x16x32_bf16 v[60:63], v[36:39], v[48:51], 0
    v_mfma_f32_16x16x32_bf16 v[64:67], v[32:35], v[52:55], 0
    v_mfma_f32_16x16x32_bf16 v[68:71], v[36:39], v[52:55], 0
    s_nop 4
    v_perm_b32 v88, v57, v56, s26
    v_perm_b32 v89, v59, v58, s26
    v_perm_b32 v90, v61, v60, s26
    v_perm_b32 v91, v63, v62, s26
    v_perm_b32 v92, v65, v64, s26
    v_perm_b32 v93, v67, v66, s26
    v_perm_b32 v94, v69, v68, s26
    v_perm_b32 v95, v71, v70, s26
    v_mfma_f32_16x16x32_bf16 v[56:59], v[40:43], v[48:51], 0
    v_mfma_f32_16x16x32_bf16 v[60:63], v[44:47], v[48:51], 0
    v_mfma_f32_16x16x32_bf16 v[64:67], v[40:43], v[52:55], 0
    v_mfma_f32_16x16x32_bf16 v[68:71], v[44:47], v[52:55], 0
    s_nop 4
    v_perm_b32 v96, v57, v56, s26
    v_perm_b32 v97, v59, v58, s26
    v_perm_b32 v98, v61, v60, s26
    v_perm_b32 v99, v63, v62, s26
    v_perm_b32 v100, v65, v64, s26
    v_perm_b32 v101, v67, v66, s26
    v_perm_b32 v102, v69, v68, s26
    v_perm_b32 v103, v71, v70, s26
    s_cmp_lg_u32 s4, 0
    s_cbranch_scc1 KB_G_WAIT
    v_lshlrev_b32 v40, 8, v0
    s_mov_b32 s24, 0
POLLK_G:
    global_load_dwordx2 v[44:45], v40, s[16:17] sc1
    global_load_dwordx2 v[46:47], v40, s[16:17] offset:128 sc1
    s_add_u32 s24, s24, 1
    s_waitcnt vmcnt(0)
    v_min_u32 v41, v44, v46
    v_cmp_eq_u32 vcc, 0, v41
    s_cmp_gt_u32 s24, 200000
    s_cbranch_scc1 POLLK_DONE_G
    s_cbranch_vccz POLLK_DONE_G
    s_sleep 2
    s_branch POLLK_G
POLLK_DONE_G:
    v_max_u32 v41, v44, v46
    s_nop 1
    v_max_u32_dpp v41, v41, v41 row_ror:8 row_mask:0xf bank_mask:0xf
    s_nop 1
    v_max_u32_dpp v41, v41, v41 row_ror:4 row_mask:0xf bank_mask:0xf
    s_nop 1
    v_max_u32_dpp v41, v41, v41 row_ror:2 row_mask:0xf bank_mask:0xf
    s_nop 1
    v_max_u32_dpp v41, v41, v41 row_ror:1 row_mask:0xf bank_mask:0xf
    s_nop 0
    v_readlane_b32 s20, v41, 0
    v_readlane_b32 s21, v41, 16
    v_readlane_b32 s22, v41, 32
    v_readlane_b32 s23, v41, 48
    s_max_u32 s20, s20, s21
    s_nop 0
    s_max_u32 s22, s22, s23
    s_max_u32 s20, s20, s22
    v_cmp_eq_u32 vcc, s20, v44
    s_nop 1
    v_cndmask_b32 v41, v47, v45, vcc
    v_cmp_eq_u32 s[22:23], s20, v46
    s_nop 1
    s_or_b64 s[22:23], s[22:23], vcc
    s_ff1_i32_b64 s22, s[22:23]
    s_and_b32 s22, s22, 63
    v_readlane_b32 s21, v41, s22
    v_mov_b32 v42, s20
    s_nop 0
    v_mov_b32 v43, s21
    ds_write_b64 v6, v[42:43] offset:4608
    s_waitcnt lgkmcnt(0)
KB_G_WAIT:
    s_barrier
    ds_read_b64 v[42:43], v6 offset:4608
    s_waitcnt lgkmcnt(0)
    v_readfirstlane_b32 s20, v42
    v_readfirstlane_b32 s21, v43
    s_nop 0
    s_and_b32 s22, s20, 0xffff
    s_sub_u32 s22, 0xffff, s22
    s_min_u32 s22, s22, 2047
    s_lshr_b32 s23, s22, 4
    s_mul_i32 s23, s23, 20480
    s_and_b32 s24, s22, 15
    s_lshl_b32 s24, s24, 1
    s_add_u32 s23, s23, s24
    s_add_u32 s23, s23, 7864320
    s_lshl_b32 s24, s21, 16
    s_and_b32 s25, s21, 0xffff0000
    v_add_u32 v5, s23, v5
    global_load_ushort v8, v5, s[6:7]
    s_lshl_b32 s13, s12, 7
    v_lshl_add_u32 v13, v0, 2, s13
    v_rcp_f32 v12, s25
    s_waitcnt vmcnt(0)
    v_lshlrev_b32 v8, 16, v8
    v_subrev_f32 v8, s24, v8
    v_cvt_pk_bf16_f32 v8, v8, v8
    v_lshlrev_b32 v8, 16, v8
    v_mul_f32 v8, v8, v12
    v_cvt_pk_bf16_f32 v8, v8, v8
    ds_write_b16 v11, v8
    s_waitcnt lgkmcnt(0)
    s_barrier
    ds_read_b128 v[40:43], v9
    ds_read_b128 v[44:47], v9 offset:64
    s_waitcnt lgkmcnt(1)
    v_mfma_f32_16x16x32_bf16 v[16:19], v[40:43], v[72:75], 0
    v_mfma_f32_16x16x32_bf16 v[20:23], v[40:43], v[76:79], 0
    v_mfma_f32_16x16x32_bf16 v[24:27], v[40:43], v[88:91], 0
    v_mfma_f32_16x16x32_bf16 v[28:31], v[40:43], v[92:95], 0
    s_waitcnt lgkmcnt(0)
    v_mfma_f32_16x16x32_bf16 v[16:19], v[44:47], v[80:83], v[16:19]
    v_mfma_f32_16x16x32_bf16 v[20:23], v[44:47], v[84:87], v[20:23]
    v_mfma_f32_16x16x32_bf16 v[24:27], v[44:47], v[96:99], v[24:27]
    v_mfma_f32_16x16x32_bf16 v[28:31], v[44:47], v[100:103], v[28:31]
    s_nop 4
    ds_write_b32 v10, v16 offset:1280
    ds_write_b32 v10, v20 offset:2048
    ds_write_b32 v10, v24 offset:2816
    ds_write_b32 v10, v28 offset:3584
    s_waitcnt lgkmcnt(0)
    s_barrier
    s_cmp_lg_u32 s4, 0
    s_cbranch_scc1 KB_END
    ds_read_b128 v[16:19], v7 offset:1280
    ds_read_b128 v[20:23], v7 offset:1296
    ds_read_b64 v[24:25], v7 offset:1312
    s_waitcnt lgkmcnt(0)
    v_pk_add_f32 v[16:17], v[16:17], v[18:19]
    v_pk_add_f32 v[20:21], v[20:21], v[22:23]
    v_pk_add_f32 v[16:17], v[16:17], v[24:25]
    v_pk_add_f32 v[16:17], v[16:17], v[20:21]
    v_add_f32 v16, v16, v17
    v_cvt_pk_bf16_f32 v16, v16, v16
    v_lshlrev_b32 v16, 16, v16
    v_mov_b32 v32, v16
    s_nop 1
    v_permlane32_swap_b32 v16, v32
    v_cmp_gt_u32 vcc, 32, v0
    s_nop 1
    s_and_saveexec_b64 s[22:23], vcc
    v_mul_f32 v17, 0xbfb8aa3b, v16
    v_exp_f32 v17, v17
    s_nop 0
    v_add_f32 v17, 1.0, v17
    v_rcp_f32 v17, v17
    s_nop 0
    v_mul_f32 v16, v16, v17
    v_cvt_pk_bf16_f32 v16, v16, v16
    v_lshlrev_b32 v16, 16, v16
    v_mul_f32 v16, v16, v32
    v_cvt_pk_bf16_f32 v16, v16, v16
    v_lshlrev_b32 v16, 16, v16
    v_or_b32 v16, 1, v16
    global_store_dword v13, v16, s[14:15] sc1
    s_endpgm
KB_D:
    s_load_dwordx4 s[8:11], s[0:1], 88
    s_sub_u32 s12, s2, 182
    s_lshr_b32 s12, s12, 3
    s_and_b32 s13, s2, 7
    s_mul_i32 s13, s13, 5
    s_add_u32 s12, s12, s13
    s_lshl_b32 s13, s12, 5
    v_and_b32 v1, 15, v0
    v_bfe_u32 v2, v0, 4, 2
    v_lshrrev_b32 v3, 6, v0
    v_lshrrev_b32 v4, 2, v1
    v_and_b32 v5, 3, v1
    v_lshl_add_u32 v4, v4, 3, v5
    v_mul_u32_u24 v5, 192, v3
    v_add_u32 v4, v4, v5
    v_mul_u32_u24 v4, 1280, v4
    v_lshl_add_u32 v4, v2, 3, v4
    v_add_u32 v4, s13, v4
    v_lshlrev_b32 v5, 5, v0
    v_readfirstlane_b32 s4, v3
    v_mul_u32_u24 v9, 384, v3
    v_lshl_add_u32 v9, v2, 4, v9
    v_lshlrev_b32 v7, 4, v0
    v_mul_u32_u24 v14, 48, v1
    v_lshl_add_u32 v12, v3, 2, v14
    v_mov_b32 v49, 0
    v_mov_b32 v28, 0
    v_mov_b32 v29, 0
    v_mov_b32 v30, 0
    v_mov_b32 v31, 0
    v_and_b32 v6, 31, v0
    v_lshlrev_b32 v6, 4, v6
    ds_write_b128 v6, v[28:31] offset:3456
    s_mov_b32 s33, 0x07060302
    v_lshlrev_b32 v8, 2, v2
    v_sub_u32 v8, v1, v8
    v_and_b32 v10, 1, v1
    v_lshlrev_b32 v10, 4, v10
    v_mov_b32 v11, 0x3f80
    v_lshlrev_b32 v10, v10, v11
    v_ashrrev_i32 v8, 1, v8
    v_cmp_eq_u32 vcc, 0, v8
    s_nop 1
    v_cndmask_b32 v54, 0, v10, vcc
    v_cmp_eq_u32 vcc, 1, v8
    s_nop 1
    v_cndmask_b32 v55, 0, v10, vcc
    s_waitcnt lgkmcnt(0)
    s_mov_b32 s28, s8
    s_mov_b32 s29, s9
    s_mov_b32 s30, 2211840
    s_mov_b32 s31, 0x00020000
    buffer_load_dwordx2 v[56:57], v4, s[28:31], 0 offen
    v_add_u32 v4, 5120, v4
    buffer_load_dwordx2 v[58:59], v4, s[28:31], 0 offen
    v_add_u32 v4, 35840, v4
    buffer_load_dwordx2 v[60:61], v4, s[28:31], 0 offen
    v_add_u32 v4, 5120, v4
    buffer_load_dwordx2 v[62:63], v4, s[28:31], 0 offen
    v_add_u32 v4, 35840, v4
    buffer_load_dwordx2 v[64:65], v4, s[28:31], 0 offen
    v_add_u32 v4, 5120, v4
    buffer_load_dwordx2 v[66:67], v4, s[28:31], 0 offen
    v_add_u32 v4, 35840, v4
    buffer_load_dwordx2 v[68:69], v4, s[28:31], 0 offen
    v_add_u32 v4, 5120, v4
    buffer_load_dwordx2 v[70:71], v4, s[28:31], 0 offen
    v_add_u32 v4, 35840, v4
    buffer_load_dwordx2 v[72:73], v4, s[28:31], 0 offen
    v_add_u32 v4, 5120, v4
    buffer_load_dwordx2 v[74:75], v4, s[28:31], 0 offen
    v_add_u32 v4, 35840, v4
    buffer_load_dwordx2 v[76:77], v4, s[28:31], 0 offen
    v_add_u32 v4, 5120, v4
    buffer_load_dwordx2 v[78:79], v4, s[28:31], 0 offen
    s_add_u32 s16, s6, 10944512
    s_addc_u32 s17, s7, 0
    s_add_u32 s14, s6, 10960896
    s_addc_u32 s15, s7, 0
    s_waitcnt vmcnt(0)
    v_mfma_f32_16x16x16_bf16 v[16:19], v[56:57], v[54:55], 0
    v_mfma_f32_16x16x16_bf16 v[20:23], v[58:59], v[54:55], 0
    v_mfma_f32_16x16x16_bf16 v[24:27], v[60:61], v[54:55], 0
    v_mfma_f32_16x16x16_bf16 v[28:31], v[62:63], v[54:55], 0
    s_nop 4
    v_perm_b32 v80, v17, v16, s33
    v_perm_b32 v81, v19, v18, s33
    v_perm_b32 v82, v21, v20, s33
    v_perm_b32 v83, v23, v22, s33
    v_mfma_f32_16x16x16_bf16 v[16:19], v[64:65], v[54:55], 0
    v_mfma_f32_16x16x16_bf16 v[20:23], v[66:67], v[54:55], 0
    v_perm_b32 v84, v25, v24, s33
    v_perm_b32 v85, v27, v26, s33
    v_perm_b32 v86, v29, v28, s33
    v_perm_b32 v87, v31, v30, s33
    v_mfma_f32_16x16x16_bf16 v[24:27], v[68:69], v[54:55], 0
    v_mfma_f32_16x16x16_bf16 v[28:31], v[70:71], v[54:55], 0
    s_nop 0
    v_perm_b32 v88, v17, v16, s33
    v_perm_b32 v89, v19, v18, s33
    v_perm_b32 v90, v21, v20, s33
    v_perm_b32 v91, v23, v22, s33
    v_mfma_f32_16x16x16_bf16 v[16:19], v[72:73], v[54:55], 0
    v_mfma_f32_16x16x16_bf16 v[20:23], v[74:75], v[54:55], 0
    v_perm_b32 v92, v25, v24, s33
    v_perm_b32 v93, v27, v26, s33
    v_perm_b32 v94, v29, v28, s33
    v_perm_b32 v95, v31, v30, s33
    v_mfma_f32_16x16x16_bf16 v[24:27], v[76:77], v[54:55], 0
    v_mfma_f32_16x16x16_bf16 v[28:31], v[78:79], v[54:55], 0
    s_nop 0
    v_perm_b32 v96, v17, v16, s33
    v_perm_b32 v97, v19, v18, s33
    v_perm_b32 v98, v21, v20, s33
    v_perm_b32 v99, v23, v22, s33
    s_nop 1
    v_perm_b32 v100, v25, v24, s33
    v_perm_b32 v101, v27, v26, s33
    v_perm_b32 v102, v29, v28, s33
    v_perm_b32 v103, v31, v30, s33
    s_cmp_lg_u32 s4, 0
    s_cbranch_scc1 KB_D_ACT
    v_lshlrev_b32 v40, 8, v0
    s_mov_b32 s24, 0
POLLK_D:
    global_load_dwordx2 v[44:45], v40, s[16:17] sc1
    global_load_dwordx2 v[46:47], v40, s[16:17] offset:128 sc1
    s_add_u32 s24, s24, 1
    s_waitcnt vmcnt(0)
    v_min_u32 v41, v44, v46
    v_cmp_eq_u32 vcc, 0, v41
    s_cmp_gt_u32 s24, 200000
    s_cbranch_scc1 POLLK_DONE_D
    s_cbranch_vccz POLLK_DONE_D
    s_sleep 2
    s_branch POLLK_D
POLLK_DONE_D:
    v_max_u32 v41, v44, v46
    s_nop 1
    v_max_u32_dpp v41, v41, v41 row_ror:8 row_mask:0xf bank_mask:0xf
    s_nop 1
    v_max_u32_dpp v41, v41, v41 row_ror:4 row_mask:0xf bank_mask:0xf
    s_nop 1
    v_max_u32_dpp v41, v41, v41 row_ror:2 row_mask:0xf bank_mask:0xf
    s_nop 1
    v_max_u32_dpp v41, v41, v41 row_ror:1 row_mask:0xf bank_mask:0xf
    s_nop 0
    v_readlane_b32 s20, v41, 0
    v_readlane_b32 s21, v41, 16
    v_readlane_b32 s22, v41, 32
    v_readlane_b32 s23, v41, 48
    s_max_u32 s20, s20, s21
    s_nop 0
    s_max_u32 s22, s22, s23
    s_max_u32 s20, s20, s22
    v_cmp_eq_u32 vcc, s20, v44
    s_nop 1
    v_cndmask_b32 v41, v47, v45, vcc
    v_cmp_eq_u32 s[22:23], s20, v46
    s_nop 1
    s_or_b64 s[22:23], s[22:23], vcc
    s_ff1_i32_b64 s22, s[22:23]
    s_and_b32 s22, s22, 63
    v_readlane_b32 s21, v41, s22
    s_and_b32 s22, s20, 0xffff
    s_sub_u32 s22, 0xffff, s22
    s_min_u32 s22, s22, 2047
    s_lshr_b32 s23, s22, 4
    s_mul_i32 s23, s23, 20480
    s_and_b32 s24, s22, 15
    s_lshl_b32 s24, s24, 1
    s_add_u32 s23, s23, s24
    s_add_u32 s23, s23, 7864320
    s_lshl_b32 s24, s21, 16
    s_and_b32 s25, s21, 0xffff0000
    s_lshl_b32 s26, s12, 4
    v_and_b32 v41, 15, v0
    v_add_u32 v41, s26, v41
    v_lshlrev_b32 v42, 5, v41
    v_add_u32 v42, s23, v42
    global_load_ushort v48, v42, s[6:7]
    s_mul_i32 s26, s22, 1280
    v_lshl_add_u32 v49, v41, 1, s26
    s_lshr_b32 s26, s22, 4
    s_lshl_b32 s26, s26, 7
    s_add_u32 s26, s26, 10977280
    v_mov_b32 v43, s26
    v_mov_b32 v44, 0
    ds_write_b32 v44, v43 offset:4992
    s_waitcnt vmcnt(0) lgkmcnt(0)
    v_lshlrev_b32 v48, 16, v48
    v_rcp_f32 v51, s25
    v_subrev_f32 v50, s24, v48
    v_cvt_pk_bf16_f32 v50, v50, v50
    v_lshlrev_b32 v50, 16, v50
    v_mul_f32 v50, v50, v51
    v_cvt_pk_bf16_f32 v50, v50, v50
    v_lshlrev_b32 v50, 16, v50
    s_lshr_b32 s26, s20, 16
    s_and_b32 s27, s26, 0x7fff
    s_xor_b32 s32, s26, 0xffff
    s_bitcmp1_b32 s26, 15
    s_cselect_b32 s26, s27, s32
    s_lshl_b32 s26, s26, 16
    v_mov_b32 v52, s26
    v_mul_f32 v52, 0xbfb8aa3b, v52
    v_exp_f32 v52, v52
    s_nop 0
    v_add_f32 v52, 1.0, v52
    v_rcp_f32 v52, v52
    s_nop 0
    v_cvt_pk_bf16_f32 v52, v52, v52
    v_lshlrev_b32 v52, 16, v52
KB_D_ACT:
    s_barrier
    s_cmp_lg_u32 s4, 9
    s_cbranch_scc1 KB_D_NOTDONE
    v_mov_b32 v44, 0
    ds_read_b32 v43, v44 offset:4992
    s_mov_b32 s27, 0
    s_waitcnt lgkmcnt(0)
KB_D_DONE:
    global_load_dword v44, v43, s[6:7] sc1
    s_add_u32 s27, s27, 1
    s_waitcnt vmcnt(0)
    v_cmp_eq_u32 vcc, 0, v44
    s_cmp_gt_u32 s27, 200000
    s_cbranch_scc1 KB_D_GO
    s_cbranch_vccz KB_D_GO
    s_sleep 2
    s_branch KB_D_DONE
KB_D_NOTDONE:
    s_cmp_ge_u32 s4, 4
    s_cbranch_scc1 KB_D_GO
    v_cmp_gt_u32 vcc, 216, v0
    s_nop 1
    s_and_saveexec_b64 s[22:23], vcc
    s_mov_b32 s24, 0
KB_D_POLL:
    global_load_dwordx4 v[24:27], v5, s[14:15] sc1
    global_load_dwordx4 v[28:31], v5, s[14:15] offset:16 sc1
    s_add_u32 s24, s24, 1
    s_waitcnt vmcnt(0)
    v_min3_u32 v32, v24, v25, v26
    v_min3_u32 v33, v27, v28, v29
    v_min3_u32 v32, v30, v31, v32
    v_min_u32 v32, v32, v33
    v_cmp_eq_u32 vcc, 0, v32
    s_cmp_gt_u32 s24, 200000
    s_cbranch_scc1 KB_D_GOT
    s_cbranch_vccz KB_D_GOT
    s_sleep 1
    s_branch KB_D_POLL
KB_D_GOT:
    v_perm_b32 v32, v25, v24, s33
    v_perm_b32 v33, v27, v26, s33
    v_perm_b32 v34, v29, v28, s33
    v_perm_b32 v35, v31, v30, s33
    ds_write_b128 v7, v[32:35]
    s_mov_b64 exec, s[22:23]
    s_waitcnt lgkmcnt(0)
KB_D_GO:
    s_barrier
    ds_read_b128 v[56:59], v9 offset:0
    ds_read_b128 v[60:63], v9 offset:64
    ds_read_b128 v[64:67], v9 offset:128
    ds_read_b128 v[68:71], v9 offset:192
    ds_read_b128 v[72:75], v9 offset:256
    ds_read_b128 v[76:79], v9 offset:320
    s_waitcnt lgkmcnt(5)
    v_mfma_f32_16x16x32_bf16 v[32:35], v[56:59], v[80:83], 0
    s_waitcnt lgkmcnt(4)
    v_mfma_f32_16x16x32_bf16 v[32:35], v[60:63], v[84:87], v[32:35]
    s_waitcnt lgkmcnt(3)
    v_mfma_f32_16x16x32_bf16 v[32:35], v[64:67], v[88:91], v[32:35]
    s_waitcnt lgkmcnt(2)
    v_mfma_f32_16x16x32_bf16 v[32:35], v[68:71], v[92:95], v[32:35]
    s_waitcnt lgkmcnt(1)
    v_mfma_f32_16x16x32_bf16 v[32:35], v[72:75], v[96:99], v[32:35]
    s_waitcnt lgkmcnt(0)
    v_mfma_f32_16x16x32_bf16 v[32:35], v[76:79], v[100:103], v[32:35]
    s_nop 7
    ds_write_b32 v12, v32 offset:4096
    s_waitcnt lgkmcnt(0)
    s_barrier
    v_cmp_gt_u32 vcc, 16, v0
    s_nop 1
    s_and_saveexec_b64 s[22:23], vcc
    s_cbranch_execz KB_END
    ds_read_b128 v[32:35], v14 offset:4096
    ds_read_b128 v[36:39], v14 offset:4112
    ds_read_b64 v[40:41], v14 offset:4128
    s_waitcnt lgkmcnt(0)
    v_pk_add_f32 v[32:33], v[32:33], v[34:35]
    v_pk_add_f32 v[36:37], v[36:37], v[38:39]
    v_pk_add_f32 v[32:33], v[32:33], v[40:41]
    v_pk_add_f32 v[32:33], v[32:33], v[36:37]
    v_add_f32 v32, v32, v33
    v_cvt_pk_bf16_f32 v32, v32, v32
    v_lshlrev_b32 v32, 16, v32
    v_mul_f32 v32, v32, v52
    v_cvt_pk_bf16_f32 v32, v32, v32
    v_lshlrev_b32 v32, 16, v32
    v_add_f32 v32, v32, v50
    v_cvt_pk_bf16_f32 v32, v32, v32
    v_lshlrev_b32 v32, 16, v32
    v_add_f32 v32, v32, v48
    v_cvt_pk_bf16_f32 v32, v32, v32
    global_store_short v49, v32, s[10:11] sc1
KB_END:
    s_endpgm
.section .rodata,"a"
.p2align 6
.amdhsa_kernel k1_kernel
  .amdhsa_next_free_vgpr 112
  .amdhsa_next_free_sgpr 32
  .amdhsa_accum_offset 112
  .amdhsa_group_segment_fixed_size 0
  .amdhsa_kernarg_size 120
  .amdhsa_user_sgpr_count 2
  .amdhsa_user_sgpr_kernarg_segment_ptr 1
  .amdhsa_system_sgpr_workgroup_id_x 1
.end_amdhsa_kernel
.p2align 6
.amdhsa_kernel k2_kernel
  .amdhsa_next_free_vgpr 168
  .amdhsa_next_free_sgpr 68
  .amdhsa_accum_offset 168
  .amdhsa_group_segment_fixed_size 0
  .amdhsa_kernarg_size 120
  .amdhsa_user_sgpr_count 2
  .amdhsa_user_sgpr_kernarg_segment_ptr 1
  .amdhsa_system_sgpr_workgroup_id_x 1
.end_amdhsa_kernel
.p2align 6
.amdhsa_kernel kb_kernel
  .amdhsa_next_free_vgpr 112
  .amdhsa_next_free_sgpr 40
  .amdhsa_accum_offset 112
  .amdhsa_group_segment_fixed_size 0
  .amdhsa_kernarg_size 120
  .amdhsa_user_sgpr_count 2
  .amdhsa_user_sgpr_kernarg_segment_ptr 1
  .amdhsa_system_sgpr_workgroup_id_x 1
.end_amdhsa_kernel
```
